```python
import torch

def _softmax(x, axis=-1):
    return torch.softmax(x, dim=axis)
def _gelu(x):
    return torch.nn.functional.gelu(x, approximate="tanh")
def _silu(x):
    return torch.nn.functional.silu(x)
def _sigmoid(x):
    return torch.sigmoid(x)
def _layernorm(x, axis=-1, eps=1e-5):
    m = x.mean(dim=axis, keepdim=True)
    v = x.var(dim=axis, keepdim=True, unbiased=False)
    return (x - m) / torch.sqrt(v + eps)
def _scatter_add(tgt, idx, src, axis=0):
    return tgt.clone().index_add_(axis, idx, src)
def _segment_sum(src, seg, n):
    out = torch.zeros((n,) + src.shape[1:], dtype=src.dtype)
    return out.index_add_(0, seg, src)
def _pad(x, pw):
    flat = tuple(v for pair in reversed(pw) for v in pair)
    return torch.nn.functional.pad(x, flat)

kernel_name = 'parallel_sum__ssm_conv_s4__moe_arch_mod__prompt'

def setup_inputs():

    _w = (lambda a: (lambda t: t.to(torch.bfloat16) if t.is_floating_point() else t)(torch.as_tensor(a)))
    def _A_setup():
        B, L, D, N = 1, 2048, 512, 128
        A_re = -(lambda _x: torch.exp(torch.as_tensor(_x)))((lambda *s: torch.randn(*s, dtype=torch.bfloat16) * 3.2)(D, N))
        A_im = torch.pi * (lambda *s: torch.randn(*s, dtype=torch.bfloat16) * 0.1)(D, N)
        B_re = (lambda *s: torch.randn(*s, dtype=torch.bfloat16) * 0.4)(D, N)
        B_im = (lambda *s: torch.randn(*s, dtype=torch.bfloat16) * 0.4)(D, N)
        C_re = (lambda *s: torch.randn(*s, dtype=torch.bfloat16) * 0.4)(D, N)
        C_im = (lambda *s: torch.randn(*s, dtype=torch.bfloat16) * 0.4)(D, N)
        log_dt = (lambda *s: torch.randn(*s, dtype=torch.bfloat16) * 0.1)(D) * 0.5 - 4.0
        Dskip = (lambda *s: torch.randn(*s, dtype=torch.bfloat16) * 0.1)(D)
        return {
            "u": _w((lambda *s: torch.randn(*s, dtype=torch.bfloat16) * 0.05)(B, L, D)),
            "A_re": _w(A_re),
            "A_im": _w(A_im),
            "B_re": _w(B_re),
            "B_im": _w(B_im),
            "C_re": _w(C_re),
            "C_im": _w(C_im),
            "log_dt": _w(log_dt),
            "Dskip": _w(Dskip),
        }
    _A_in = _A_setup()

    def _B_setup():
        B, S, D, F, C = 1, 2048, 512, 1792, 2
        return {
            "x": _w((lambda *s: torch.randn(*s, dtype=torch.bfloat16) * 0.05)(B, S, D)),
            "w_r": _w((lambda *s: torch.randn(*s, dtype=torch.bfloat16) * 0.05)(D)),
            "w_gate": _w((lambda *s: torch.randn(*s, dtype=torch.bfloat16) * 0.05)(D, F)),
            "w_up": _w((lambda *s: torch.randn(*s, dtype=torch.bfloat16) * 0.05)(D, F)),
            "w_down": _w((lambda *s: torch.randn(*s, dtype=torch.bfloat16) * 0.05)(F, D)),
        }
    _B_in = _B_setup()

    return {
        "A_u": _A_in["u"],
        "A_A_re": _A_in["A_re"],
        "A_A_im": _A_in["A_im"],
        "A_B_re": _A_in["B_re"],
        "A_B_im": _A_in["B_im"],
        "A_C_re": _A_in["C_re"],
        "A_C_im": _A_in["C_im"],
        "A_log_dt": _A_in["log_dt"],
        "A_Dskip": _A_in["Dskip"],
        "B_x": _B_in["x"],
        "B_w_r": _B_in["w_r"],
        "B_w_gate": _B_in["w_gate"],
        "B_w_up": _B_in["w_up"],
        "B_w_down": _B_in["w_down"],
    }

def reference(A_u, A_A_re, A_A_im, A_B_re, A_B_im, A_C_re, A_C_im, A_log_dt, A_Dskip, B_x, B_w_r, B_w_gate, B_w_up, B_w_down):
    def _A_ref(u, A_re, A_im, B_re, B_im, C_re, C_im, log_dt, Dskip):
        Bsz, L, D = u.shape
        dt = torch.exp(log_dt)[:, None]
        A = A_re + 1j * A_im
        Bc = B_re + 1j * B_im
        Cc = C_re + 1j * C_im
        logdA = dt * A
        dB = dt * Bc
        l = (lambda x, dt: x.to(dt))(torch.arange(L), A_re.dtype)
        P = torch.exp(logdA[:, :, None] * l[None, None, :])
        K = torch.einsum("dn,dnl,dn->dl", Cc, P, dB).real
        L2 = 2 * L
        Kp = _pad(K, ((0, 0), (0, L)))
        up = (lambda x, *d: x.permute(*d))(u, 0, 2, 1)
        up = _pad(up, ((0, 0), (0, 0), (0, L)))
        Kf = (lambda x, axes=(-2,-1): torch.fft.rfft2(x.float(), dim=axes))(Kp[:, None, :], axes=(-2, -1))
        Uf = (lambda x, axes=(-2,-1): torch.fft.rfft2(x.float(), dim=axes))(up[:, :, None, :], axes=(-2, -1))
        Yf = Uf * Kf[None, :, :, :]
        y = (lambda x, s, axes=(-2,-1): torch.fft.irfft2(x, s=s, dim=axes).to(torch.bfloat16))(Yf, (1, L2), axes=(-2, -1))[:, :, 0, :L]
        y = (lambda x, *d: x.permute(*d))(y, 0, 2, 1) + u * Dskip[None, None, :]
        return y

    def _B_ref(x, w_r, w_gate, w_up, w_down):
        B, S, D = x.shape
        C = 2
        r = x @ w_r
        idx = torch.argsort(-r, axis=-1)[:, :C]
        idx_e = (lambda x, n, axis: torch.repeat_interleave(x, n, dim=axis))(idx.reshape(B, C, 1), D, axis=2)
        x_sel = (lambda x, i, axis: torch.take_along_dim(x, i, dim=axis))(x, idx_e, axis=1)
        g = _silu(x_sel @ w_gate)
        u = x_sel @ w_up
        y = (g * u) @ w_down
        r_sel = _sigmoid((lambda x, i, axis: torch.take_along_dim(x, i, dim=axis))(r, idx, axis=1))
        y = y * r_sel.reshape(B, C, 1)
        b_off = (torch.arange(B) * S).reshape(B, 1)
        flat_idx = (idx + b_off).reshape(B * C)
        zero = (x * 0.0).reshape(B * S, D)
        upd = _scatter_add(zero, flat_idx, y.reshape(B * C, D), axis=0)
        return x + upd.reshape(B, S, D)

    x = A_u
    xn = _layernorm(x, axis=-1)
    return x + _A_ref(xn, A_A_re, A_A_im, A_B_re, A_B_im, A_C_re, A_C_im, A_log_dt, A_Dskip) + _B_ref(xn, B_w_r, B_w_gate, B_w_up, B_w_down)
```

```asm
; @launch grid=(496,1,1) block=(256,1,1) lds=67328
.amdgcn_target "amdgcn-amd-amdhsa--gfx950"
.text
.globl parallel_sum__ssm_conv_s4__moe_arch_mod__prompt_kernel
.p2align 8
.type parallel_sum__ssm_conv_s4__moe_arch_mod__prompt_kernel,@function
parallel_sum__ssm_conv_s4__moe_arch_mod__prompt_kernel:
    s_cmp_ge_u32 s2, 496
    s_cbranch_scc1 L_end
    s_load_dwordx16 s[8:23], s[0:1], 0
    s_load_dwordx16 s[24:39], s[0:1], 64
    s_load_dwordx2 s[40:41], s[0:1], 128
    v_and_b32 v1, 63, v0
    v_lshrrev_b32 v3, 6, v0
    v_mov_b32 v2, 0
    v_readfirstlane_b32 s42, v3
    s_mov_b32 s74, 0xffff0000
    v_lshlrev_b32 v11, 4, v1
    s_cmp_ge_u32 s2, 128
    s_cbranch_scc1 L_stub
    s_setprio 3
    s_lshl_b32 s47, s2, 4
    s_lshl_b32 s48, s42, 2
    s_add_u32 s47, s47, s48
    s_lshl_b32 s48, s47, 10
    v_add_u32 v10, s48, v11
    s_waitcnt lgkmcnt(0)
    global_load_dwordx4 v[12:15], v10, s[8:9] offset:0
    global_load_dwordx4 v[16:19], v10, s[8:9] offset:1024
    global_load_dwordx4 v[20:23], v10, s[8:9] offset:2048
    global_load_dwordx4 v[24:27], v10, s[8:9] offset:3072
    global_load_dwordx4 v[28:31], v11, s[28:29]
    s_branch L_ln_main
L_stub:
    s_cmp_ge_u32 s2, 384
    s_cbranch_scc1 L_notln
    s_sub_u32 s47, s2, 128
    s_and_b32 s48, s47, 7
    s_lshl_b32 s48, s48, 5
    s_lshr_b32 s49, s47, 3
    s_add_u32 s43, s48, s49
    s_lshl_b32 s48, s43, 9
    s_lshl_b32 s49, s42, 7
    s_add_u32 s48, s48, s49
    v_lshl_add_u32 v30, v1, 1, s48
    v_mov_b32 v24, 0
    v_mov_b32 v25, 0
    v_mov_b32 v26, 0
    v_mov_b32 v27, 0
    v_mov_b32 v28, 0
    v_mov_b32 v29, 0
    s_lshl_b32 s49, s43, 2
    s_waitcnt lgkmcnt(0)
    global_load_short_d16_hi v24, v30, s[10:11]
    global_load_short_d16_hi v25, v30, s[12:13]
    global_load_short_d16_hi v26, v30, s[14:15]
    global_load_short_d16_hi v27, v30, s[16:17]
    global_load_short_d16_hi v28, v30, s[18:19]
    global_load_short_d16_hi v29, v30, s[20:21]
    s_load_dword s45, s[22:23], s49
    s_load_dword s46, s[24:25], s49
    s_branch L_notln
L_ln_main:
    s_getpc_b64 s[66:67]
L_pc:
    s_sub_u32 s66, s66, L_pc-parallel_sum__ssm_conv_s4__moe_arch_mod__prompt_kernel
    s_subb_u32 s67, s67, 0
    v_lshlrev_b32 v145, 6, v0
    v_min_u32 v145, L_end-parallel_sum__ssm_conv_s4__moe_arch_mod__prompt_kernel, v145
    s_cmp_ge_u32 s2, 64
    s_cbranch_scc1 L_nocp
    global_load_dword v159, v145, s[66:67]
    s_branch L_cpdone
L_nocp:
    global_load_dword v159, v2, s[28:29]
L_cpdone:
    s_add_u32 s4, s40, 8388608
    s_addc_u32 s5, s41, 0
    s_mul_i32 s50, s42, 4160
    v_add_u32 v142, s50, v11
    v_and_b32 v145, 3, v0
    v_lshrrev_b32 v146, 2, v0
    v_mul_u32_u24 v143, 4160, v145
    v_lshl_add_u32 v143, v146, 2, v143
    s_lshl_b32 s50, s2, 6
    v_lshl_add_u32 v144, v145, 4, s50
    v_lshl_add_u32 v144, v146, 13, v144
    s_lshl_b32 s50, s47, 3
    v_add_u32 v10, s50, v11
    s_and_b32 s48, s2, 7
    s_lshr_b32 s49, s2, 3
    s_sub_u32 s50, s42, 1
    s_cmp_ge_u32 s50, 2
    s_cbranch_scc1 L_pf_down
    s_mul_i32 s50, s48, 448
    s_mul_i32 s51, s49, 57344
    s_add_u32 s50, s50, s51
    s_add_u32 s50, s50, 917504
    v_lshrrev_b32 v176, 2, v1
    v_mul_u32_u24 v176, 3584, v176
    v_and_b32 v177, 3, v1
    v_mul_u32_u24 v177, 148, v177
    v_add3_u32 v176, v176, v177, s50
    s_cmp_eq_u32 s42, 1
    s_cselect_b32 s66, s30, s32
    s_cselect_b32 s67, s31, s33
    v_add_u32 v177, 72, v176
    v_min_u32 v177, 1835004, v177
    s_branch L_pf_go
L_pf_down:
    s_mul_i32 s50, s48, 229376
    s_mul_i32 s51, s49, 14336
    s_add_u32 s50, s50, s51
    s_and_b32 s51, s42, 1
    s_mul_i32 s51, s51, 7168
    s_add_u32 s50, s50, s51
    v_min_u32 v176, 55, v1
    v_lshl_add_u32 v176, v176, 6, s50
    v_add_u32 v177, 3584, v176
    s_mov_b64 s[66:67], s[34:35]
L_pf_go:
    v_mov_b32 v147, 0x3b000000
    v_mov_b32 v148, 0x3f803f80
    v_mov_b32 v136, 0
    v_mov_b32 v137, 0
    v_mov_b32 v138, 0
    v_mov_b32 v139, 0
    v_mov_b32 v140, 0
    s_waitcnt vmcnt(5)
    ds_write_b128 v142, v[12:15] offset:16896
    v_lshlrev_b32 v32, 16, v12
    v_and_b32 v33, s74, v12
    v_lshlrev_b32 v34, 16, v13
    v_and_b32 v35, s74, v13
    v_lshlrev_b32 v36, 16, v14
    v_and_b32 v37, s74, v14
    v_lshlrev_b32 v38, 16, v15
    v_and_b32 v39, s74, v15
    s_waitcnt vmcnt(4)
    ds_write_b128 v142, v[16:19] offset:17936
    v_lshlrev_b32 v40, 16, v16
    v_and_b32 v41, s74, v16
    v_lshlrev_b32 v42, 16, v17
    v_and_b32 v43, s74, v17
    v_lshlrev_b32 v44, 16, v18
    v_and_b32 v45, s74, v18
    v_lshlrev_b32 v46, 16, v19
    v_and_b32 v47, s74, v19
    s_waitcnt vmcnt(3)
    ds_write_b128 v142, v[20:23] offset:18976
    v_lshlrev_b32 v48, 16, v20
    v_and_b32 v49, s74, v20
    v_lshlrev_b32 v50, 16, v21
    v_and_b32 v51, s74, v21
    v_lshlrev_b32 v52, 16, v22
    v_and_b32 v53, s74, v22
    v_lshlrev_b32 v54, 16, v23
    v_and_b32 v55, s74, v23
    s_waitcnt vmcnt(2)
    ds_write_b128 v142, v[24:27] offset:20016
    s_waitcnt lgkmcnt(0)
    s_barrier
    ds_read_b32 v160, v143 offset:16896
    ds_read_b32 v161, v143 offset:17936
    ds_read_b32 v162, v143 offset:18976
    ds_read_b32 v163, v143 offset:20016
    ds_read_b32 v164, v143 offset:17152
    ds_read_b32 v165, v143 offset:18192
    ds_read_b32 v166, v143 offset:19232
    ds_read_b32 v167, v143 offset:20272
    ds_read_b32 v168, v143 offset:17408
    ds_read_b32 v169, v143 offset:18448
    ds_read_b32 v170, v143 offset:19488
    ds_read_b32 v171, v143 offset:20528
    ds_read_b32 v172, v143 offset:17664
    ds_read_b32 v173, v143 offset:18704
    ds_read_b32 v174, v143 offset:19744
    ds_read_b32 v175, v143 offset:20784
    v_lshlrev_b32 v56, 16, v24
    v_and_b32 v57, s74, v24
    v_lshlrev_b32 v58, 16, v25
    v_and_b32 v59, s74, v25
    v_lshlrev_b32 v60, 16, v26
    v_and_b32 v61, s74, v26
    v_lshlrev_b32 v62, 16, v27
    v_and_b32 v63, s74, v27
    v_readfirstlane_b32 s52, v32
    v_readfirstlane_b32 s54, v40
    v_readfirstlane_b32 s56, v48
    v_readfirstlane_b32 s58, v56
    s_waitcnt lgkmcnt(12)
    global_store_dwordx4 v144, v[160:163], s[4:5] sc1
    v_add_u32 v144, 0x80000, v144
    s_waitcnt lgkmcnt(8)
    global_store_dwordx4 v144, v[164:167], s[4:5] sc1
    v_add_u32 v144, 0x80000, v144
    s_waitcnt lgkmcnt(4)
    global_store_dwordx4 v144, v[168:171], s[4:5] sc1
    v_add_u32 v144, 0x80000, v144
    s_waitcnt lgkmcnt(0)
    global_store_dwordx4 v144, v[172:175], s[4:5] sc1
    global_load_dword v141, v2, s[38:39] sc1
    v_pk_add_f32 v[64:65], v[32:33], s[52:53] op_sel_hi:[1,0] neg_lo:[0,1] neg_hi:[0,1]
    v_pk_add_f32 v[72:73], v[40:41], s[54:55] op_sel_hi:[1,0] neg_lo:[0,1] neg_hi:[0,1]
    v_pk_add_f32 v[80:81], v[48:49], s[56:57] op_sel_hi:[1,0] neg_lo:[0,1] neg_hi:[0,1]
    v_pk_add_f32 v[88:89], v[56:57], s[58:59] op_sel_hi:[1,0] neg_lo:[0,1] neg_hi:[0,1]
    v_pk_add_f32 v[66:67], v[34:35], s[52:53] op_sel_hi:[1,0] neg_lo:[0,1] neg_hi:[0,1]
    v_pk_add_f32 v[74:75], v[42:43], s[54:55] op_sel_hi:[1,0] neg_lo:[0,1] neg_hi:[0,1]
    v_pk_add_f32 v[82:83], v[50:51], s[56:57] op_sel_hi:[1,0] neg_lo:[0,1] neg_hi:[0,1]
    v_pk_add_f32 v[90:91], v[58:59], s[58:59] op_sel_hi:[1,0] neg_lo:[0,1] neg_hi:[0,1]
    v_pk_add_f32 v[68:69], v[36:37], s[52:53] op_sel_hi:[1,0] neg_lo:[0,1] neg_hi:[0,1]
    v_pk_add_f32 v[76:77], v[44:45], s[54:55] op_sel_hi:[1,0] neg_lo:[0,1] neg_hi:[0,1]
    v_pk_add_f32 v[84:85], v[52:53], s[56:57] op_sel_hi:[1,0] neg_lo:[0,1] neg_hi:[0,1]
    v_pk_add_f32 v[92:93], v[60:61], s[58:59] op_sel_hi:[1,0] neg_lo:[0,1] neg_hi:[0,1]
    v_pk_add_f32 v[70:71], v[38:39], s[52:53] op_sel_hi:[1,0] neg_lo:[0,1] neg_hi:[0,1]
    v_pk_add_f32 v[78:79], v[46:47], s[54:55] op_sel_hi:[1,0] neg_lo:[0,1] neg_hi:[0,1]
    v_pk_add_f32 v[86:87], v[54:55], s[56:57] op_sel_hi:[1,0] neg_lo:[0,1] neg_hi:[0,1]
    v_pk_add_f32 v[94:95], v[62:63], s[58:59] op_sel_hi:[1,0] neg_lo:[0,1] neg_hi:[0,1]
    s_waitcnt vmcnt(6)
    v_dot2c_f32_bf16 v136, v12, v28
    v_dot2c_f32_bf16 v137, v16, v28
    v_dot2c_f32_bf16 v138, v20, v28
    v_dot2c_f32_bf16 v139, v24, v28
    v_dot2c_f32_bf16 v140, v148, v28
    v_dot2c_f32_bf16 v136, v13, v29
    v_dot2c_f32_bf16 v137, v17, v29
    v_dot2c_f32_bf16 v138, v21, v29
    v_dot2c_f32_bf16 v139, v25, v29
    v_dot2c_f32_bf16 v140, v148, v29
    v_dot2c_f32_bf16 v136, v14, v30
    v_dot2c_f32_bf16 v137, v18, v30
    v_dot2c_f32_bf16 v138, v22, v30
    v_dot2c_f32_bf16 v139, v26, v30
    v_dot2c_f32_bf16 v140, v148, v30
    v_dot2c_f32_bf16 v136, v15, v31
    v_dot2c_f32_bf16 v137, v19, v31
    v_dot2c_f32_bf16 v138, v23, v31
    v_dot2c_f32_bf16 v139, v27, v31
    v_dot2c_f32_bf16 v140, v148, v31
    v_pk_add_f32 v[96:97], v[64:65], v[66:67]
    v_pk_add_f32 v[104:105], v[72:73], v[74:75]
    v_pk_add_f32 v[112:113], v[80:81], v[82:83]
    v_pk_add_f32 v[120:121], v[88:89], v[90:91]
    v_pk_mul_f32 v[100:101], v[64:65], v[64:65]
    v_pk_mul_f32 v[108:109], v[72:73], v[72:73]
    v_pk_mul_f32 v[116:117], v[80:81], v[80:81]
    v_pk_mul_f32 v[124:125], v[88:89], v[88:89]
    v_pk_add_f32 v[98:99], v[68:69], v[70:71]
    v_pk_add_f32 v[106:107], v[76:77], v[78:79]
    v_pk_add_f32 v[114:115], v[84:85], v[86:87]
    v_pk_add_f32 v[122:123], v[92:93], v[94:95]
    v_pk_fma_f32 v[100:101], v[66:67], v[66:67], v[100:101]
    v_pk_fma_f32 v[108:109], v[74:75], v[74:75], v[108:109]
    v_pk_fma_f32 v[116:117], v[82:83], v[82:83], v[116:117]
    v_pk_fma_f32 v[124:125], v[90:91], v[90:91], v[124:125]
    v_pk_add_f32 v[96:97], v[96:97], v[98:99]
    v_pk_add_f32 v[104:105], v[104:105], v[106:107]
    v_pk_add_f32 v[112:113], v[112:113], v[114:115]
    v_pk_add_f32 v[120:121], v[120:121], v[122:123]
    v_pk_fma_f32 v[100:101], v[68:69], v[68:69], v[100:101]
    v_pk_fma_f32 v[108:109], v[76:77], v[76:77], v[108:109]
    v_pk_fma_f32 v[116:117], v[84:85], v[84:85], v[116:117]
    v_pk_fma_f32 v[124:125], v[92:93], v[92:93], v[124:125]
    v_add_f32 v128, v96, v97
    v_add_f32 v129, v104, v105
    v_add_f32 v130, v112, v113
    v_add_f32 v131, v120, v121
    v_pk_fma_f32 v[100:101], v[70:71], v[70:71], v[100:101]
    v_pk_fma_f32 v[108:109], v[78:79], v[78:79], v[108:109]
    v_pk_fma_f32 v[116:117], v[86:87], v[86:87], v[116:117]
    v_pk_fma_f32 v[124:125], v[94:95], v[94:95], v[124:125]
    v_add_f32 v132, v100, v101
    v_add_f32 v133, v108, v109
    v_add_f32 v134, v116, v117
    v_add_f32 v135, v124, v125
    v_add_f32_dpp v128, v128, v128 quad_perm:[1,0,3,2] row_mask:0xf bank_mask:0xf
    v_add_f32_dpp v129, v129, v129 quad_perm:[1,0,3,2] row_mask:0xf bank_mask:0xf
    v_add_f32_dpp v130, v130, v130 quad_perm:[1,0,3,2] row_mask:0xf bank_mask:0xf
    v_add_f32_dpp v131, v131, v131 quad_perm:[1,0,3,2] row_mask:0xf bank_mask:0xf
    v_add_f32_dpp v136, v136, v136 quad_perm:[1,0,3,2] row_mask:0xf bank_mask:0xf
    v_add_f32_dpp v137, v137, v137 quad_perm:[1,0,3,2] row_mask:0xf bank_mask:0xf
    v_add_f32_dpp v138, v138, v138 quad_perm:[1,0,3,2] row_mask:0xf bank_mask:0xf
    v_add_f32_dpp v139, v139, v139 quad_perm:[1,0,3,2] row_mask:0xf bank_mask:0xf
    v_add_f32_dpp v140, v140, v140 quad_perm:[1,0,3,2] row_mask:0xf bank_mask:0xf
    v_add_f32_dpp v132, v132, v132 quad_perm:[1,0,3,2] row_mask:0xf bank_mask:0xf
    v_add_f32_dpp v133, v133, v133 quad_perm:[1,0,3,2] row_mask:0xf bank_mask:0xf
    v_add_f32_dpp v134, v134, v134 quad_perm:[1,0,3,2] row_mask:0xf bank_mask:0xf
    v_add_f32_dpp v135, v135, v135 quad_perm:[1,0,3,2] row_mask:0xf bank_mask:0xf
    v_add_f32_dpp v128, v128, v128 quad_perm:[2,3,0,1] row_mask:0xf bank_mask:0xf
    v_add_f32_dpp v129, v129, v129 quad_perm:[2,3,0,1] row_mask:0xf bank_mask:0xf
    v_add_f32_dpp v130, v130, v130 quad_perm:[2,3,0,1] row_mask:0xf bank_mask:0xf
    v_add_f32_dpp v131, v131, v131 quad_perm:[2,3,0,1] row_mask:0xf bank_mask:0xf
    v_add_f32_dpp v136, v136, v136 quad_perm:[2,3,0,1] row_mask:0xf bank_mask:0xf
    v_add_f32_dpp v137, v137, v137 quad_perm:[2,3,0,1] row_mask:0xf bank_mask:0xf
    v_add_f32_dpp v138, v138, v138 quad_perm:[2,3,0,1] row_mask:0xf bank_mask:0xf
    v_add_f32_dpp v139, v139, v139 quad_perm:[2,3,0,1] row_mask:0xf bank_mask:0xf
    v_add_f32_dpp v140, v140, v140 quad_perm:[2,3,0,1] row_mask:0xf bank_mask:0xf
    v_add_f32_dpp v132, v132, v132 quad_perm:[2,3,0,1] row_mask:0xf bank_mask:0xf
    v_add_f32_dpp v133, v133, v133 quad_perm:[2,3,0,1] row_mask:0xf bank_mask:0xf
    v_add_f32_dpp v134, v134, v134 quad_perm:[2,3,0,1] row_mask:0xf bank_mask:0xf
    v_add_f32_dpp v135, v135, v135 quad_perm:[2,3,0,1] row_mask:0xf bank_mask:0xf
    v_add_f32_dpp v128, v128, v128 row_half_mirror row_mask:0xf bank_mask:0xf
    v_add_f32_dpp v129, v129, v129 row_half_mirror row_mask:0xf bank_mask:0xf
    v_add_f32_dpp v130, v130, v130 row_half_mirror row_mask:0xf bank_mask:0xf
    v_add_f32_dpp v131, v131, v131 row_half_mirror row_mask:0xf bank_mask:0xf
    v_add_f32_dpp v136, v136, v136 row_half_mirror row_mask:0xf bank_mask:0xf
    v_add_f32_dpp v137, v137, v137 row_half_mirror row_mask:0xf bank_mask:0xf
    v_add_f32_dpp v138, v138, v138 row_half_mirror row_mask:0xf bank_mask:0xf
    v_add_f32_dpp v139, v139, v139 row_half_mirror row_mask:0xf bank_mask:0xf
    v_add_f32_dpp v140, v140, v140 row_half_mirror row_mask:0xf bank_mask:0xf
    v_add_f32_dpp v132, v132, v132 row_half_mirror row_mask:0xf bank_mask:0xf
    v_add_f32_dpp v133, v133, v133 row_half_mirror row_mask:0xf bank_mask:0xf
    v_add_f32_dpp v134, v134, v134 row_half_mirror row_mask:0xf bank_mask:0xf
    v_add_f32_dpp v135, v135, v135 row_half_mirror row_mask:0xf bank_mask:0xf
    v_add_f32_dpp v128, v128, v128 row_mirror row_mask:0xf bank_mask:0xf
    v_add_f32_dpp v129, v129, v129 row_mirror row_mask:0xf bank_mask:0xf
    v_add_f32_dpp v130, v130, v130 row_mirror row_mask:0xf bank_mask:0xf
    v_add_f32_dpp v131, v131, v131 row_mirror row_mask:0xf bank_mask:0xf
    v_add_f32_dpp v136, v136, v136 row_mirror row_mask:0xf bank_mask:0xf
    v_add_f32_dpp v137, v137, v137 row_mirror row_mask:0xf bank_mask:0xf
    v_add_f32_dpp v138, v138, v138 row_mirror row_mask:0xf bank_mask:0xf
    v_add_f32_dpp v139, v139, v139 row_mirror row_mask:0xf bank_mask:0xf
    v_add_f32_dpp v140, v140, v140 row_mirror row_mask:0xf bank_mask:0xf
    v_add_f32_dpp v132, v132, v132 row_mirror row_mask:0xf bank_mask:0xf
    v_add_f32_dpp v133, v133, v133 row_mirror row_mask:0xf bank_mask:0xf
    v_add_f32_dpp v134, v134, v134 row_mirror row_mask:0xf bank_mask:0xf
    v_add_f32_dpp v135, v135, v135 row_mirror row_mask:0xf bank_mask:0xf
    v_add_f32_dpp v128, v128, v128 row_bcast:15 row_mask:0xa bank_mask:0xf
    v_add_f32_dpp v129, v129, v129 row_bcast:15 row_mask:0xa bank_mask:0xf
    v_add_f32_dpp v130, v130, v130 row_bcast:15 row_mask:0xa bank_mask:0xf
    v_add_f32_dpp v131, v131, v131 row_bcast:15 row_mask:0xa bank_mask:0xf
    v_add_f32_dpp v136, v136, v136 row_bcast:15 row_mask:0xa bank_mask:0xf
    v_add_f32_dpp v137, v137, v137 row_bcast:15 row_mask:0xa bank_mask:0xf
    v_add_f32_dpp v138, v138, v138 row_bcast:15 row_mask:0xa bank_mask:0xf
    v_add_f32_dpp v139, v139, v139 row_bcast:15 row_mask:0xa bank_mask:0xf
    v_add_f32_dpp v140, v140, v140 row_bcast:15 row_mask:0xa bank_mask:0xf
    v_add_f32_dpp v132, v132, v132 row_bcast:15 row_mask:0xa bank_mask:0xf
    v_add_f32_dpp v133, v133, v133 row_bcast:15 row_mask:0xa bank_mask:0xf
    v_add_f32_dpp v134, v134, v134 row_bcast:15 row_mask:0xa bank_mask:0xf
    v_add_f32_dpp v135, v135, v135 row_bcast:15 row_mask:0xa bank_mask:0xf
    v_add_f32_dpp v128, v128, v128 row_bcast:31 row_mask:0xc bank_mask:0xf
    v_add_f32_dpp v129, v129, v129 row_bcast:31 row_mask:0xc bank_mask:0xf
    v_add_f32_dpp v130, v130, v130 row_bcast:31 row_mask:0xc bank_mask:0xf
    v_add_f32_dpp v131, v131, v131 row_bcast:31 row_mask:0xc bank_mask:0xf
    v_add_f32_dpp v136, v136, v136 row_bcast:31 row_mask:0xc bank_mask:0xf
    v_add_f32_dpp v137, v137, v137 row_bcast:31 row_mask:0xc bank_mask:0xf
    v_add_f32_dpp v138, v138, v138 row_bcast:31 row_mask:0xc bank_mask:0xf
    v_add_f32_dpp v139, v139, v139 row_bcast:31 row_mask:0xc bank_mask:0xf
    v_add_f32_dpp v140, v140, v140 row_bcast:31 row_mask:0xc bank_mask:0xf
    v_add_f32_dpp v132, v132, v132 row_bcast:31 row_mask:0xc bank_mask:0xf
    v_add_f32_dpp v133, v133, v133 row_bcast:31 row_mask:0xc bank_mask:0xf
    v_add_f32_dpp v134, v134, v134 row_bcast:31 row_mask:0xc bank_mask:0xf
    v_add_f32_dpp v135, v135, v135 row_bcast:31 row_mask:0xc bank_mask:0xf
    v_mul_f32 v128, v147, v128
    v_mul_f32 v129, v147, v129
    v_mul_f32 v130, v147, v130
    v_mul_f32 v131, v147, v131
    v_mul_f32 v132, v147, v132
    v_mul_f32 v133, v147, v133
    v_mul_f32 v134, v147, v134
    v_mul_f32 v135, v147, v135
    v_fma_f32 v132, -v128, v128, v132
    v_fma_f32 v133, -v129, v129, v133
    v_fma_f32 v134, -v130, v130, v134
    v_fma_f32 v135, -v131, v131, v135
    v_add_f32 v128, s52, v128
    v_add_f32 v129, s54, v129
    v_add_f32 v130, s56, v130
    v_add_f32 v131, s58, v131
    v_max_f32 v132, 0, v132
    v_max_f32 v133, 0, v133
    v_max_f32 v134, 0, v134
    v_max_f32 v135, 0, v135
    v_cvt_pk_bf16_f32 v96, v128, v129
    v_cvt_pk_bf16_f32 v97, v130, v131
    v_cvt_pk_bf16_f32 v98, v132, v133
    v_cvt_pk_bf16_f32 v99, v134, v135
    v_lshlrev_b32 v128, 16, v96
    v_and_b32 v129, s74, v96
    v_lshlrev_b32 v130, 16, v97
    v_and_b32 v131, s74, v97
    v_lshlrev_b32 v132, 16, v98
    v_and_b32 v133, s74, v98
    v_lshlrev_b32 v134, 16, v99
    v_and_b32 v135, s74, v99
    v_add_f32 v132, 0x3727c5ac, v132
    v_add_f32 v133, 0x3727c5ac, v133
    v_add_f32 v134, 0x3727c5ac, v134
    v_add_f32 v135, 0x3727c5ac, v135
    v_fma_f32 v136, -v128, v140, v136
    v_fma_f32 v137, -v129, v140, v137
    v_fma_f32 v138, -v130, v140, v138
    v_fma_f32 v139, -v131, v140, v139
    v_cvt_pk_bf16_f32 v98, v132, v133
    v_cvt_pk_bf16_f32 v99, v134, v135
    v_lshrrev_b32 v128, 16, v128
    v_lshrrev_b32 v129, 16, v129
    v_lshrrev_b32 v130, 16, v130
    v_lshrrev_b32 v131, 16, v131
    v_lshlrev_b32 v132, 16, v98
    v_and_b32 v133, s74, v98
    v_lshlrev_b32 v134, 16, v99
    v_and_b32 v135, s74, v99
    v_sqrt_f32 v132, v132
    v_sqrt_f32 v133, v133
    v_sqrt_f32 v134, v134
    v_sqrt_f32 v135, v135
    s_nop 0
    v_cvt_pk_bf16_f32 v98, v132, v133
    v_cvt_pk_bf16_f32 v99, v134, v135
    v_lshlrev_b32 v132, 16, v98
    v_and_b32 v133, s74, v98
    v_lshlrev_b32 v134, 16, v99
    v_and_b32 v135, s74, v99
    v_rcp_f32 v104, v132
    v_rcp_f32 v105, v133
    v_rcp_f32 v106, v134
    v_rcp_f32 v107, v135
    v_or_b32 v128, v128, v132
    v_or_b32 v129, v129, v133
    v_or_b32 v130, v130, v134
    v_or_b32 v131, v131, v135
    v_mul_f32 v136, v136, v104
    v_mul_f32 v137, v137, v105
    v_mul_f32 v138, v138, v106
    v_mul_f32 v139, v139, v107
    v_readlane_b32 s10, v128, 63
    v_readlane_b32 s11, v129, 63
    v_readlane_b32 s12, v130, 63
    v_readlane_b32 s13, v131, 63
    v_cvt_pk_bf16_f32 v96, v136, v137
    v_cvt_pk_bf16_f32 v97, v138, v139
    v_cmp_eq_u32 vcc, 0, v1
    v_readlane_b32 s56, v96, 63
    v_readlane_b32 s57, v97, 63
    v_mov_b32 v152, s12
    v_mov_b32 v154, s13
    v_mov_b32 v145, s10
    v_mov_b32 v146, s11
    v_cndmask_b32 v152, v152, v145, vcc
    v_cndmask_b32 v154, v154, v146, vcc
    s_sub_u32 s51, 0xffff, s47
    s_and_b32 s48, s56, 0x80008000
    s_lshr_b32 s49, s48, 15
    s_mul_i32 s49, s49, 0x7fff
    s_or_b32 s49, s49, 0x80008000
    s_xor_b32 s50, s56, s49
    s_lshl_b32 s48, s50, 16
    s_or_b32 s48, s48, s51
    s_sub_u32 s51, s51, 1
    s_and_b32 s49, s50, 0xffff0000
    s_or_b32 s49, s49, s51
    s_sub_u32 s51, s51, 1
    s_max_u32 s14, s48, s49
    s_min_u32 s15, s48, s49
    s_and_b32 s48, s57, 0x80008000
    s_lshr_b32 s49, s48, 15
    s_mul_i32 s49, s49, 0x7fff
    s_or_b32 s49, s49, 0x80008000
    s_xor_b32 s50, s57, s49
    s_lshl_b32 s48, s50, 16
    s_or_b32 s48, s48, s51
    s_sub_u32 s51, s51, 1
    s_and_b32 s49, s50, 0xffff0000
    s_or_b32 s49, s49, s51
    s_sub_u32 s51, s51, 1
    s_max_u32 s16, s48, s49
    s_min_u32 s17, s48, s49
    s_max_u32 s48, s14, s16
    s_min_u32 s49, s14, s16
    s_max_u32 s50, s15, s17
    s_max_u32 s49, s49, s50
    v_mov_b32 v156, s48
    v_mov_b32 v157, s49
    s_lshl_b32 s48, s42, 3
    v_mov_b32 v158, s48
    ds_write_b64 v158, v[156:157] offset:64
    s_mov_b32 s64, 0
L_npoll_1:
    s_waitcnt vmcnt(0)
L_npoll_1_chk:
    v_readfirstlane_b32 s44, v141
    s_add_u32 s64, s64, 1
    s_cmp_lg_u32 s44, 0
    s_cbranch_scc1 L_npoll_1_done
    s_cmp_ge_u32 s64, 40000
    s_cbranch_scc1 L_npoll_1_done
    s_sleep 1
    global_load_dword v141, v2, s[38:39] sc1
    s_branch L_npoll_1
L_npoll_1_done:
    v_mov_b32 v153, v141
    v_mov_b32 v155, v141
    s_mov_b64 exec, 3
    global_store_dwordx4 v10, v[152:155], s[40:41] sc1
    s_mov_b64 exec, -1
    s_waitcnt lgkmcnt(0)
    s_barrier
    s_cmp_lg_u32 s42, 0
    s_cbranch_scc1 L_ln_pf
    ds_read_b128 v[96:99], v2 offset:64
    ds_read_b128 v[100:103], v2 offset:80
    s_lshl_b32 s48, s2, 7
    s_add_u32 s48, s48, 16384
    v_mov_b32 v105, s48
    s_waitcnt lgkmcnt(0)
    v_max_u32 v104, v97, v99
    v_med3_u32 v97, v96, v98, v104
    v_max_u32 v96, v96, v98
    v_max_u32 v104, v97, v101
    v_med3_u32 v97, v96, v100, v104
    v_max_u32 v96, v96, v100
    v_max_u32 v104, v97, v103
    v_med3_u32 v97, v96, v102, v104
    v_max_u32 v96, v96, v102
    v_mov_b32 v98, v97
    v_mov_b32 v97, v141
    v_mov_b32 v99, v141
    s_mov_b64 exec, 1
    global_store_dwordx4 v105, v[96:99], s[40:41] sc1
    s_mov_b64 exec, -1
L_ln_pf:
    s_barrier
    global_load_dword v178, v176, s[66:67]
    global_load_dword v179, v177, s[66:67]
    s_waitcnt vmcnt(0)
    s_branch L_fin
L_notln:
    v_and_b32 v5, 15, v1
    v_lshrrev_b32 v6, 4, v1
    v_lshlrev_b32 v252, 7, v1
    v_add_u32 v253, 24576, v252
    v_add_u32 v252, 16384, v252
    s_cmp_ge_u32 s2, 384
    s_cbranch_scc1 L_ffn
    s_lshr_b32 s48, s47, 3
    s_xor_b32 s48, s48, 31
    s_xor_b32 s49, s42, 3
    s_or_b32 s48, s48, s49
    s_cmp_lg_u32 s48, 0
    s_cbranch_scc1 L_nocas_2
    s_memrealtime s[50:51]
    s_waitcnt lgkmcnt(0)
    s_or_b32 s50, s50, 1
    v_mov_b32 v32, s50
    v_mov_b32 v33, 0
    s_mov_b64 exec, 1
    global_atomic_cmpswap v2, v[32:33], s[38:39] sc1
    s_mov_b64 exec, -1
L_nocas_2:
    s_add_u32 s70, s40, 65536
    s_addc_u32 s71, s41, 0
    s_lshl_b32 s48, s43, 13
    s_add_u32 s48, s48, 8388608
    s_add_u32 s68, s40, s48
    s_addc_u32 s69, s41, 0
    v_lshlrev_b32 v235, 4, v0
    v_lshlrev_b32 v237, 3, v0
    v_lshlrev_b32 v238, 2, v0
    s_lshl_b32 s50, s42, 11
    s_add_u32 s50, s50, 42752
    v_lshl_add_u32 v234, v6, 7, s50
    v_lshl_add_u32 v236, v1, 5, s50
    v_add_u32 v248, 0, v235
    v_add_u32 v249, 4096, v235
    v_add_u32 v250, 8192, v235
    v_add_u32 v251, 12288, v235
    v_add_u32 v239, 4096, v237
    v_mov_b32 v12, v5
    v_cmp_eq_u32 vcc, 8, v5
    v_mov_b32 v13, 512
    s_nop 0
    v_cndmask_b32 v12, v12, v13, vcc
    v_cmp_eq_u32 vcc, 9, v5
    v_mov_b32 v13, 516
    s_nop 0
    v_cndmask_b32 v12, v12, v13, vcc
    v_cmp_eq_u32 vcc, 10, v5
    v_mov_b32 v13, 1024
    s_nop 0
    v_cndmask_b32 v12, v12, v13, vcc
    v_cmp_eq_u32 vcc, 11, v5
    v_mov_b32 v13, 1536
    s_nop 0
    v_cndmask_b32 v12, v12, v13, vcc
    v_cmp_eq_u32 vcc, 12, v5
    v_mov_b32 v13, 2048
    s_nop 0
    v_cndmask_b32 v12, v12, v13, vcc
    v_cmp_eq_u32 vcc, 13, v5
    v_mov_b32 v13, 0
    s_nop 0
    v_cndmask_b32 v12, v12, v13, vcc
    v_cmp_eq_u32 vcc, 14, v5
    v_mov_b32 v13, 0
    s_nop 0
    v_cndmask_b32 v12, v12, v13, vcc
    v_cmp_eq_u32 vcc, 15, v5
    v_mov_b32 v13, 0
    s_nop 0
    v_cndmask_b32 v12, v12, v13, vcc
    v_cvt_f32_u32 v200, v12
    v_lshlrev_b32 v12, 3, v5
    v_cvt_f32_u32 v206, v12
    s_lshr_b32 s48, s42, 1
    s_mul_i32 s48, s48, 7680
    s_and_b32 s49, s42, 1
    s_lshl_b32 s49, s49, 2
    s_add_u32 s48, s48, s49
    s_add_u32 s48, s48, 50944
    v_mul_u32_u24 v12, 9, v5
    v_lshl_add_u32 v12, v6, 2, v12
    v_cmp_eq_u32 s[50:51], 2, v6
    v_cmp_eq_u32 s[52:53], 3, v6
    v_cmp_eq_u32 s[54:55], 48, v1
    v_add_u32 v13, 0, v12
    v_lshl_add_u32 v14, v5, 1, v2
    v_add_u32 v14, 576, v14
    v_cndmask_b32 v13, v13, v14, s[50:51]
    v_add_u32 v14, 848, v5
    v_cndmask_b32 v13, v13, v14, s[52:53]
    v_mov_b32 v14, 832
    v_cndmask_b32 v13, v13, v14, s[54:55]
    v_lshl_add_u32 v208, v13, 3, s48
    v_add_u32 v13, 1, v12
    v_lshl_add_u32 v14, v5, 1, v2
    v_add_u32 v14, 577, v14
    v_cndmask_b32 v13, v13, v14, s[50:51]
    v_add_u32 v14, 864, v5
    v_cndmask_b32 v13, v13, v14, s[52:53]
    v_lshl_add_u32 v209, v13, 3, s48
    v_add_u32 v13, 2, v12
    v_add_u32 v14, 704, v5
    v_cndmask_b32 v13, v13, v14, s[50:51]
    v_add_u32 v14, 880, v5
    v_cndmask_b32 v13, v13, v14, s[52:53]
    v_lshl_add_u32 v210, v13, 3, s48
    v_add_u32 v13, 3, v12
    v_add_u32 v14, 768, v5
    v_cndmask_b32 v13, v13, v14, s[50:51]
    v_add_u32 v14, 896, v5
    v_cndmask_b32 v13, v13, v14, s[52:53]
    v_lshl_add_u32 v211, v13, 3, s48
    v_mov_b32 v13, 1152
    v_mov_b32 v14, 256
    v_cndmask_b32 v13, v13, v14, s[50:51]
    v_cndmask_b32 v13, v13, v2, s[52:53]
    v_mov_b32 v14, 128
    v_cndmask_b32 v13, v13, v14, s[54:55]
    v_mov_b32 v202, v13
    v_mov_b32 v13, 1152
    v_mov_b32 v14, 128
    v_cndmask_b32 v13, v13, v14, s[50:51]
    v_cndmask_b32 v13, v13, v2, s[52:53]
    v_mov_b32 v203, v13
    v_sub_u32 v12, 2047, v237
    s_movk_i32 s49, 0x4400
    v_mov_b32 v15, 840
    v_subrev_u32 v13, 0, v12
    v_cvt_f32_i32 v14, v13
    v_cvt_pk_bf16_f32 v14, v14, v2
    v_lshlrev_b32 v16, 16, v14
    v_cmp_gt_u32 vcc, s49, v14
    v_cvt_u32_f32 v16, v16
    v_subrev_u32 v14, 16832, v14
    v_lshrrev_b32 v17, 3, v16
    v_add_u32 v16, v16, v17
    v_cndmask_b32 v14, v14, v16, vcc
    v_lshlrev_b32 v212, 3, v14
    v_subrev_u32 v13, 1, v12
    v_cvt_f32_i32 v14, v13
    v_cvt_pk_bf16_f32 v14, v14, v2
    v_lshlrev_b32 v16, 16, v14
    v_cmp_gt_u32 vcc, s49, v14
    v_cvt_u32_f32 v16, v16
    v_subrev_u32 v14, 16832, v14
    v_lshrrev_b32 v17, 3, v16
    v_add_u32 v16, v16, v17
    v_cndmask_b32 v14, v14, v16, vcc
    v_lshlrev_b32 v213, 3, v14
    v_subrev_u32 v13, 2, v12
    v_cvt_f32_i32 v14, v13
    v_cvt_pk_bf16_f32 v14, v14, v2
    v_lshlrev_b32 v16, 16, v14
    v_cmp_gt_u32 vcc, s49, v14
    v_cvt_u32_f32 v16, v16
    v_subrev_u32 v14, 16832, v14
    v_lshrrev_b32 v17, 3, v16
    v_add_u32 v16, v16, v17
    v_cndmask_b32 v14, v14, v16, vcc
    v_lshlrev_b32 v214, 3, v14
    v_subrev_u32 v13, 3, v12
    v_cvt_f32_i32 v14, v13
    v_cvt_pk_bf16_f32 v14, v14, v2
    v_lshlrev_b32 v16, 16, v14
    v_cmp_gt_u32 vcc, s49, v14
    v_cvt_u32_f32 v16, v16
    v_subrev_u32 v14, 16832, v14
    v_lshrrev_b32 v17, 3, v16
    v_add_u32 v16, v16, v17
    v_cndmask_b32 v14, v14, v16, vcc
    v_lshlrev_b32 v215, 3, v14
    v_subrev_u32 v13, 4, v12
    v_cvt_f32_i32 v14, v13
    v_cvt_pk_bf16_f32 v14, v14, v2
    v_lshlrev_b32 v16, 16, v14
    v_cmp_gt_u32 vcc, s49, v14
    v_cvt_u32_f32 v16, v16
    v_subrev_u32 v14, 16832, v14
    v_lshrrev_b32 v17, 3, v16
    v_add_u32 v16, v16, v17
    v_cndmask_b32 v14, v14, v16, vcc
    v_lshlrev_b32 v216, 3, v14
    v_subrev_u32 v13, 5, v12
    v_cvt_f32_i32 v14, v13
    v_cvt_pk_bf16_f32 v14, v14, v2
    v_lshlrev_b32 v16, 16, v14
    v_cmp_gt_u32 vcc, s49, v14
    v_cvt_u32_f32 v16, v16
    v_subrev_u32 v14, 16832, v14
    v_lshrrev_b32 v17, 3, v16
    v_add_u32 v16, v16, v17
    v_cndmask_b32 v14, v14, v16, vcc
    v_lshlrev_b32 v217, 3, v14
    v_subrev_u32 v13, 6, v12
    v_cvt_f32_i32 v14, v13
    v_cvt_pk_bf16_f32 v14, v14, v2
    v_lshlrev_b32 v16, 16, v14
    v_cmp_gt_u32 vcc, s49, v14
    v_cvt_u32_f32 v16, v16
    v_subrev_u32 v14, 16832, v14
    v_lshrrev_b32 v17, 3, v16
    v_add_u32 v16, v16, v17
    v_cndmask_b32 v14, v14, v16, vcc
    v_lshlrev_b32 v218, 3, v14
    v_subrev_u32 v13, 7, v12
    v_cvt_f32_i32 v14, v13
    v_cvt_pk_bf16_f32 v14, v14, v2
    v_lshlrev_b32 v16, 16, v14
    v_cmp_gt_u32 vcc, s49, v14
    v_cvt_u32_f32 v16, v16
    v_subrev_u32 v14, 16832, v14
    v_lshrrev_b32 v17, 3, v16
    v_add_u32 v16, v16, v17
    v_cndmask_b32 v14, v14, v16, vcc
    v_lshlrev_b32 v219, 3, v14
    v_subrev_u32 v13, 8, v12
    v_cvt_f32_i32 v14, v13
    v_cvt_pk_bf16_f32 v14, v14, v2
    v_lshlrev_b32 v16, 16, v14
    v_cmp_gt_u32 vcc, s49, v14
    v_cvt_u32_f32 v16, v16
    v_subrev_u32 v14, 16832, v14
    v_lshrrev_b32 v17, 3, v16
    v_add_u32 v16, v16, v17
    v_cndmask_b32 v14, v14, v16, vcc
    v_cmp_gt_i32 vcc, 0, v13
    s_nop 1
    v_cndmask_b32 v14, v14, v15, vcc
    v_lshlrev_b32 v220, 3, v14
    v_subrev_u32 v13, 9, v12
    v_cvt_f32_i32 v14, v13
    v_cvt_pk_bf16_f32 v14, v14, v2
    v_lshlrev_b32 v16, 16, v14
    v_cmp_gt_u32 vcc, s49, v14
    v_cvt_u32_f32 v16, v16
    v_subrev_u32 v14, 16832, v14
    v_lshrrev_b32 v17, 3, v16
    v_add_u32 v16, v16, v17
    v_cndmask_b32 v14, v14, v16, vcc
    v_cmp_gt_i32 vcc, 0, v13
    s_nop 1
    v_cndmask_b32 v14, v14, v15, vcc
    v_lshlrev_b32 v221, 3, v14
    v_subrev_u32 v13, 10, v12
    v_cvt_f32_i32 v14, v13
    v_cvt_pk_bf16_f32 v14, v14, v2
    v_lshlrev_b32 v16, 16, v14
    v_cmp_gt_u32 vcc, s49, v14
    v_cvt_u32_f32 v16, v16
    v_subrev_u32 v14, 16832, v14
    v_lshrrev_b32 v17, 3, v16
    v_add_u32 v16, v16, v17
    v_cndmask_b32 v14, v14, v16, vcc
    v_cmp_gt_i32 vcc, 0, v13
    s_nop 1
    v_cndmask_b32 v14, v14, v15, vcc
    v_lshlrev_b32 v222, 3, v14
    s_lshr_b32 s48, s42, 1
    s_and_b32 s49, s42, 1
    s_mul_i32 s50, s48, 16640
    s_lshl_b32 s51, s49, 8
    s_sub_u32 s50, s50, s51
    s_add_u32 s50, s50, 12808
    v_and_b32 v12, 3, v5
    v_mul_u32_u24 v12, 4160, v12
    v_lshrrev_b32 v13, 2, v5
    v_lshl_add_u32 v12, v13, 3, v12
    v_lshl_add_u32 v12, v6, 4, v12
    v_sub_u32 v226, s50, v12
    s_mul_i32 s50, s48, 4608
    s_sub_u32 s50, s50, s51
    s_add_u32 s50, s50, 33872
    v_lshlrev_b32 v12, 5, v5
    v_lshlrev_b32 v13, 4, v6
    v_sub_u32 v12, v12, v13
    v_add_u32 v227, s50, v12
    s_lshl_b32 s50, s42, 11
    v_add_u32 v228, s50, v11
    s_lshr_b32 s50, s42, 1
    s_lshl_b32 s50, s50, 10
    s_and_b32 s51, s42, 1
    s_lshl_b32 s51, s51, 3
    s_add_u32 s50, s50, s51
    v_add_u32 v229, s50, v11
    s_lshr_b32 s50, s50, 2
    v_lshl_add_u32 v230, v5, 4, s50
    v_lshl_add_u32 v230, v6, 2, v230
    v_lshlrev_b32 v242, 2, v230
    v_lshlrev_b32 v243, 1, v230
    s_lshl_b32 s50, s43, 2
    v_lshl_add_u32 v232, v230, 10, s50
    v_mov_b32 v38, 0
    v_mov_b32 v39, 0
    ds_write_b64 v2, v[38:39] offset:57664
    ds_write_b64 v2, v[38:39] offset:65344
    v_lshlrev_b32 v13, 1, v0
    ds_write_b16 v13, v2 offset:33536
    ds_write_b16 v13, v2 offset:38144
    v_lshrrev_b32 v14, 5, v0
    v_mul_u32_u24 v14, 4160, v14
    v_and_b32 v15, 31, v0
    v_lshl_add_u32 v14, v15, 1, v14
    ds_write_b16 v14, v2 offset:4352
    s_waitcnt lgkmcnt(0)
    s_lshr_b32 s48, s42, 1
    s_lshl_b32 s48, s48, 4
    s_lshr_b32 s49, s45, s48
    s_lshl_b32 s49, s49, 16
    s_lshl_b32 s60, s46, 16
    s_and_b32 s61, s46, 0xffff0000
    v_mov_b32 v40, 0x3fb8aa3b
    v_mov_b32 v43, 0x32a57060
    v_add_f32 v8, s60, 1.0
    v_add_f32 v9, s61, 1.0
    v_mul_f32 v41, s49, v40
    v_fma_f32 v42, s49, v40, -v41
    v_fma_f32 v42, s49, v43, v42
    v_exp_f32 v41, v41
    v_mul_f32 v42, 0x3f317218, v42
    v_readfirstlane_b32 s60, v8
    v_readfirstlane_b32 s61, v9
    v_fma_f32 v41, v41, v42, v41
    v_cvt_pk_bf16_f32 v41, v41, v41
    v_lshlrev_b32 v44, 16, v41
    s_waitcnt vmcnt(1)
    v_mul_f32 v41, v44, v26
    v_mul_f32 v42, v44, v27
    v_mul_f32 v48, v44, v24
    v_mul_f32 v49, v44, v25
    v_mul_f32 v50, v28, v41
    v_mul_f32 v51, v28, v42
    v_mul_f32 v48, v40, v48
    v_mul_f32 v49, 0.15915494, v49
    s_lshr_b32 s48, s47, 3
    s_xor_b32 s48, s48, 31
    s_xor_b32 s50, s42, 3
    s_or_b32 s48, s48, s50
    s_cmp_eq_u32 s48, 0
    s_cbranch_scc1 L_p5b
    s_waitcnt vmcnt(0)
L_p5b:
    v_mul_f32 v56, 0x43000000, v48
    v_mul_f32 v57, 0x43000000, v49
    v_exp_f32 v56, v56
    v_fract_f32 v57, v57
    v_cos_f32 v52, v57
    v_sin_f32 v53, v57
    v_fma_f32 v50, -v29, v42, v50
    v_fma_f32 v51, v29, v41, v51
    v_max_f32 v43, |v50|, |v51|
    v_mul_f32 v52, v52, v56
    v_mul_f32 v53, v53, v56
    ds_write_b64 v236, v[52:53] offset:16
    s_nop 1
    v_max_f32_dpp v43, v43, v43 quad_perm:[1,0,3,2] row_mask:0xf bank_mask:0xf
    s_nop 1
    v_max_f32_dpp v43, v43, v43 quad_perm:[2,3,0,1] row_mask:0xf bank_mask:0xf
    s_nop 1
    v_max_f32_dpp v43, v43, v43 row_half_mirror row_mask:0xf bank_mask:0xf
    s_nop 1
    v_max_f32_dpp v43, v43, v43 row_mirror row_mask:0xf bank_mask:0xf
    s_nop 1
    v_max_f32_dpp v43, v43, v43 row_bcast:15 row_mask:0xa bank_mask:0xf
    s_nop 1
    v_max_f32_dpp v43, v43, v43 row_bcast:31 row_mask:0xc bank_mask:0xf
    s_nop 0
    v_readlane_b32 s48, v43, 63
    s_nop 3
    s_bfe_u32 s48, s48, 0x80017
    s_max_u32 s48, s48, 1
    s_min_u32 s48, s48, 253
    s_lshl_b32 s62, s48, 23
    s_sub_u32 s48, 254, s48
    s_lshl_b32 s48, s48, 23
    v_mul_f32 v50, s48, v50
    v_mul_f32 v51, s48, v51
    ds_write_b128 v236, v[48:51]
    global_load_dword v246, v2, s[38:39] sc1
    v_mov_b32 v100, 0
    v_mov_b32 v101, 0
    v_mov_b32 v102, 0
    v_mov_b32 v103, 0
    v_mov_b32 v104, 0
    v_mov_b32 v105, 0
    v_mov_b32 v106, 0
    v_mov_b32 v107, 0
    v_mov_b32 v108, 0
    v_mov_b32 v109, 0
    v_mov_b32 v110, 0
    v_mov_b32 v111, 0
    v_mov_b32 v112, 0
    v_mov_b32 v113, 0
    v_mov_b32 v114, 0
    v_mov_b32 v115, 0
    s_mov_b32 s64, 0
    s_waitcnt lgkmcnt(0)
L_kgen:
    ds_read_b128 v[56:59], v234 offset:0
    ds_read_b64 v[60:61], v234 offset:16
    ds_read_b128 v[64:67], v234 offset:32
    ds_read_b64 v[68:69], v234 offset:48
    ds_read_b128 v[72:75], v234 offset:64
    ds_read_b64 v[76:77], v234 offset:80
    ds_read_b128 v[80:83], v234 offset:96
    ds_read_b64 v[84:85], v234 offset:112
    v_add_u32 v234, 512, v234
    s_waitcnt lgkmcnt(4)
    v_pk_mul_f32 v[136:137], v[56:57], v[206:207] op_sel_hi:[1,0]
    v_pk_mul_f32 v[140:141], v[56:57], v[200:201] op_sel_hi:[1,0]
    v_pk_mul_f32 v[152:153], v[64:65], v[206:207] op_sel_hi:[1,0]
    v_pk_mul_f32 v[156:157], v[64:65], v[200:201] op_sel_hi:[1,0]
    v_fract_f32 v137, v137
    v_fract_f32 v141, v141
    v_fract_f32 v153, v153
    v_fract_f32 v157, v157
    v_exp_f32 v136, v136
    v_exp_f32 v140, v140
    v_exp_f32 v152, v152
    v_exp_f32 v156, v156
    v_cos_f32 v138, v137
    v_cos_f32 v142, v141
    v_cos_f32 v154, v153
    v_cos_f32 v158, v157
    v_sin_f32 v139, v137
    v_sin_f32 v143, v141
    v_sin_f32 v155, v153
    v_sin_f32 v159, v157
    v_pk_mul_f32 v[144:145], v[138:139], v[136:137] op_sel_hi:[1,0]
    v_pk_mul_f32 v[146:147], v[142:143], v[140:141] op_sel_hi:[1,0]
    v_pk_mul_f32 v[160:161], v[154:155], v[152:153] op_sel_hi:[1,0]
    v_pk_mul_f32 v[162:163], v[158:159], v[156:157] op_sel_hi:[1,0]
    v_pk_mul_f32 v[148:149], v[144:145], v[58:59] op_sel_hi:[0,1] neg_hi:[0,1]
    v_pk_mul_f32 v[164:165], v[160:161], v[66:67] op_sel_hi:[0,1] neg_hi:[0,1]
    v_cvt_pk_f16_f32 v116, v146, v147
    v_cvt_pk_f16_f32 v117, v162, v163
    v_fma_f32 v148, -v145, v59, v148
    v_fma_f32 v164, -v161, v67, v164
    v_fma_f32 v149, -v145, v58, v149
    v_fma_f32 v165, -v161, v66, v165
    v_pk_mul_f32 v[150:151], v[148:149], v[60:61] op_sel_hi:[1,0]
    v_pk_mul_f32 v[166:167], v[164:165], v[68:69] op_sel_hi:[1,0]
    v_cvt_pk_f16_f32 v120, v148, v149
    v_cvt_pk_f16_f32 v121, v164, v165
    v_fma_f32 v150, v149, v61, v150
    v_fma_f32 v166, v165, v69, v166
    v_fma_f32 v151, -v148, v61, v151
    v_fma_f32 v167, -v164, v69, v167
    v_pk_mul_f32 v[148:149], v[150:151], v[60:61] op_sel_hi:[1,0]
    v_pk_mul_f32 v[164:165], v[166:167], v[68:69] op_sel_hi:[1,0]
    v_cvt_pk_f16_f32 v124, v150, v151
    v_cvt_pk_f16_f32 v125, v166, v167
    v_fma_f32 v148, v151, v61, v148
    v_fma_f32 v164, v167, v69, v164
    v_fma_f32 v149, -v150, v61, v149
    v_fma_f32 v165, -v166, v69, v165
    v_pk_mul_f32 v[150:151], v[148:149], v[60:61] op_sel_hi:[1,0]
    v_pk_mul_f32 v[166:167], v[164:165], v[68:69] op_sel_hi:[1,0]
    v_cvt_pk_f16_f32 v128, v148, v149
    v_cvt_pk_f16_f32 v129, v164, v165
    v_fma_f32 v150, v149, v61, v150
    v_fma_f32 v166, v165, v69, v166
    v_fma_f32 v151, -v148, v61, v151
    v_fma_f32 v167, -v164, v69, v167
    v_cvt_pk_f16_f32 v132, v150, v151
    v_cvt_pk_f16_f32 v133, v166, v167
    s_waitcnt lgkmcnt(0)
    v_pk_mul_f32 v[136:137], v[72:73], v[206:207] op_sel_hi:[1,0]
    v_pk_mul_f32 v[140:141], v[72:73], v[200:201] op_sel_hi:[1,0]
    v_pk_mul_f32 v[152:153], v[80:81], v[206:207] op_sel_hi:[1,0]
    v_pk_mul_f32 v[156:157], v[80:81], v[200:201] op_sel_hi:[1,0]
    v_fract_f32 v137, v137
    v_fract_f32 v141, v141
    v_fract_f32 v153, v153
    v_fract_f32 v157, v157
    v_exp_f32 v136, v136
    v_exp_f32 v140, v140
    v_exp_f32 v152, v152
    v_exp_f32 v156, v156
    v_cos_f32 v138, v137
    v_cos_f32 v142, v141
    v_cos_f32 v154, v153
    v_cos_f32 v158, v157
    v_sin_f32 v139, v137
    v_sin_f32 v143, v141
    v_sin_f32 v155, v153
    v_sin_f32 v159, v157
    v_pk_mul_f32 v[144:145], v[138:139], v[136:137] op_sel_hi:[1,0]
    v_pk_mul_f32 v[146:147], v[142:143], v[140:141] op_sel_hi:[1,0]
    v_pk_mul_f32 v[160:161], v[154:155], v[152:153] op_sel_hi:[1,0]
    v_pk_mul_f32 v[162:163], v[158:159], v[156:157] op_sel_hi:[1,0]
    v_pk_mul_f32 v[148:149], v[144:145], v[74:75] op_sel_hi:[0,1] neg_hi:[0,1]
    v_pk_mul_f32 v[164:165], v[160:161], v[82:83] op_sel_hi:[0,1] neg_hi:[0,1]
    v_cvt_pk_f16_f32 v118, v146, v147
    v_cvt_pk_f16_f32 v119, v162, v163
    v_fma_f32 v148, -v145, v75, v148
    v_fma_f32 v164, -v161, v83, v164
    v_fma_f32 v149, -v145, v74, v149
    v_fma_f32 v165, -v161, v82, v165
    v_pk_mul_f32 v[150:151], v[148:149], v[76:77] op_sel_hi:[1,0]
    v_pk_mul_f32 v[166:167], v[164:165], v[84:85] op_sel_hi:[1,0]
    v_cvt_pk_f16_f32 v122, v148, v149
    v_cvt_pk_f16_f32 v123, v164, v165
    v_fma_f32 v150, v149, v77, v150
    v_fma_f32 v166, v165, v85, v166
    v_fma_f32 v151, -v148, v77, v151
    v_fma_f32 v167, -v164, v85, v167
    v_pk_mul_f32 v[148:149], v[150:151], v[76:77] op_sel_hi:[1,0]
    v_pk_mul_f32 v[164:165], v[166:167], v[84:85] op_sel_hi:[1,0]
    v_cvt_pk_f16_f32 v126, v150, v151
    v_cvt_pk_f16_f32 v127, v166, v167
    v_fma_f32 v148, v151, v77, v148
    v_fma_f32 v164, v167, v85, v164
    v_fma_f32 v149, -v150, v77, v149
    v_fma_f32 v165, -v166, v85, v165
    v_pk_mul_f32 v[150:151], v[148:149], v[76:77] op_sel_hi:[1,0]
    v_pk_mul_f32 v[166:167], v[164:165], v[84:85] op_sel_hi:[1,0]
    v_cvt_pk_f16_f32 v130, v148, v149
    v_cvt_pk_f16_f32 v131, v164, v165
    v_fma_f32 v150, v149, v77, v150
    v_fma_f32 v166, v165, v85, v166
    v_fma_f32 v151, -v148, v77, v151
    v_fma_f32 v167, -v164, v85, v167
    v_cvt_pk_f16_f32 v134, v150, v151
    v_cvt_pk_f16_f32 v135, v166, v167
    s_add_u32 s64, s64, 1
    s_cmp_lt_u32 s64, 4
    v_mfma_f32_16x16x32_f16 v[100:103], v[116:119], v[120:123], v[100:103]
    v_mfma_f32_16x16x32_f16 v[104:107], v[116:119], v[124:127], v[104:107]
    v_mfma_f32_16x16x32_f16 v[108:111], v[116:119], v[128:131], v[108:111]
    v_mfma_f32_16x16x32_f16 v[112:115], v[116:119], v[132:135], v[112:115]
    s_cbranch_scc1 L_kgen
    s_mov_b32 s64, 0
L_npoll_3:
    s_waitcnt vmcnt(0)
L_npoll_3_chk:
    v_readfirstlane_b32 s44, v246
    s_add_u32 s64, s64, 1
    s_cmp_lg_u32 s44, 0
    s_cbranch_scc1 L_npoll_3_done
    s_cmp_ge_u32 s64, 40000
    s_cbranch_scc1 L_npoll_3_done
    s_sleep 1
    global_load_dword v246, v2, s[38:39] sc1
    s_branch L_npoll_3
L_npoll_3_done:
    v_mul_f32 v100, s62, v100
    v_mul_f32 v101, s62, v101
    v_mul_f32 v102, s62, v102
    v_mul_f32 v103, s62, v103
    v_mul_f32 v104, s62, v104
    v_mul_f32 v105, s62, v105
    v_mul_f32 v106, s62, v106
    v_mul_f32 v107, s62, v107
    v_mul_f32 v108, s62, v108
    v_mul_f32 v109, s62, v109
    v_mul_f32 v110, s62, v110
    v_mul_f32 v111, s62, v111
    v_mul_f32 v112, s62, v112
    v_mul_f32 v113, s62, v113
    v_mul_f32 v114, s62, v114
    v_mul_f32 v115, s62, v115
    ds_write_b32 v208, v100
    v_add_u32 v208, v208, v202
    ds_write_b32 v209, v101
    v_add_u32 v209, v209, v202
    ds_write_b32 v210, v102
    v_add_u32 v210, v210, v203
    ds_write_b32 v211, v103
    v_add_u32 v211, v211, v203
    ds_write_b32 v208, v104
    v_add_u32 v208, v208, v202
    ds_write_b32 v209, v105
    v_add_u32 v209, v209, v202
    ds_write_b32 v210, v106
    v_add_u32 v210, v210, v203
    ds_write_b32 v211, v107
    v_add_u32 v211, v211, v203
    ds_write_b32 v208, v108
    v_add_u32 v208, v208, v202
    ds_write_b32 v209, v109
    v_add_u32 v209, v209, v202
    ds_write_b32 v210, v110
    v_add_u32 v210, v210, v203
    ds_write_b32 v211, v111
    v_add_u32 v211, v211, v203
    ds_write_b32 v208, v112
    ds_write_b32 v209, v113
    ds_write_b32 v210, v114
    ds_write_b32 v211, v115
    s_waitcnt lgkmcnt(0)
    s_barrier
    ds_read_b64 v[40:41], v212 offset:50944
    ds_read_b64 v[42:43], v213 offset:50944
    ds_read_b64 v[44:45], v214 offset:50944
    ds_read_b64 v[46:47], v215 offset:50944
    ds_read_b64 v[48:49], v216 offset:50944
    ds_read_b64 v[50:51], v217 offset:50944
    ds_read_b64 v[52:53], v218 offset:50944
    ds_read_b64 v[54:55], v219 offset:50944
    ds_read_b64 v[56:57], v220 offset:50944
    ds_read_b64 v[58:59], v221 offset:50944
    ds_read_b64 v[60:61], v222 offset:50944
    ds_read_b64 v[64:65], v212 offset:58624
    ds_read_b64 v[66:67], v213 offset:58624
    ds_read_b64 v[68:69], v214 offset:58624
    ds_read_b64 v[70:71], v215 offset:58624
    ds_read_b64 v[72:73], v216 offset:58624
    ds_read_b64 v[74:75], v217 offset:58624
    ds_read_b64 v[76:77], v218 offset:58624
    ds_read_b64 v[78:79], v219 offset:58624
    ds_read_b64 v[80:81], v220 offset:58624
    ds_read_b64 v[82:83], v221 offset:58624
    ds_read_b64 v[84:85], v222 offset:58624
    s_waitcnt lgkmcnt(11)
    v_add_f32 v40, v40, v41
    v_add_f32 v42, v42, v43
    v_add_f32 v44, v44, v45
    v_add_f32 v46, v46, v47
    v_add_f32 v48, v48, v49
    v_add_f32 v50, v50, v51
    v_add_f32 v52, v52, v53
    v_add_f32 v54, v54, v55
    v_add_f32 v56, v56, v57
    v_add_f32 v58, v58, v59
    v_add_f32 v60, v60, v61
    v_cvt_pk_bf16_f32 v96, v40, v42
    v_cvt_pk_bf16_f32 v97, v44, v46
    v_cvt_pk_bf16_f32 v98, v48, v50
    v_cvt_pk_bf16_f32 v99, v52, v54
    ds_write_b128 v235, v[96:99] offset:256
    v_cvt_pk_bf16_f32 v100, v42, v44
    v_cvt_pk_bf16_f32 v101, v46, v48
    v_cvt_pk_bf16_f32 v102, v50, v52
    v_cvt_pk_bf16_f32 v103, v54, v56
    ds_write_b128 v235, v[100:103] offset:4416
    v_cvt_pk_bf16_f32 v104, v44, v46
    v_cvt_pk_bf16_f32 v105, v48, v50
    v_cvt_pk_bf16_f32 v106, v52, v54
    v_cvt_pk_bf16_f32 v107, v56, v58
    ds_write_b128 v235, v[104:107] offset:8576
    v_cvt_pk_bf16_f32 v108, v46, v48
    v_cvt_pk_bf16_f32 v109, v50, v52
    v_cvt_pk_bf16_f32 v110, v54, v56
    v_cvt_pk_bf16_f32 v111, v58, v60
    ds_write_b128 v235, v[108:111] offset:12736
    s_waitcnt lgkmcnt(4)
    v_add_f32 v64, v64, v65
    v_add_f32 v66, v66, v67
    v_add_f32 v68, v68, v69
    v_add_f32 v70, v70, v71
    v_add_f32 v72, v72, v73
    v_add_f32 v74, v74, v75
    v_add_f32 v76, v76, v77
    v_add_f32 v78, v78, v79
    v_add_f32 v80, v80, v81
    v_add_f32 v82, v82, v83
    v_add_f32 v84, v84, v85
    v_cvt_pk_bf16_f32 v112, v64, v66
    v_cvt_pk_bf16_f32 v113, v68, v70
    v_cvt_pk_bf16_f32 v114, v72, v74
    v_cvt_pk_bf16_f32 v115, v76, v78
    ds_write_b128 v235, v[112:115] offset:16896
    v_cvt_pk_bf16_f32 v116, v66, v68
    v_cvt_pk_bf16_f32 v117, v70, v72
    v_cvt_pk_bf16_f32 v118, v74, v76
    v_cvt_pk_bf16_f32 v119, v78, v80
    ds_write_b128 v235, v[116:119] offset:21056
    v_cvt_pk_bf16_f32 v120, v68, v70
    v_cvt_pk_bf16_f32 v121, v72, v74
    v_cvt_pk_bf16_f32 v122, v76, v78
    v_cvt_pk_bf16_f32 v123, v80, v82
    ds_write_b128 v235, v[120:123] offset:25216
    v_cvt_pk_bf16_f32 v124, v70, v72
    v_cvt_pk_bf16_f32 v125, v74, v76
    v_cvt_pk_bf16_f32 v126, v78, v80
    v_cvt_pk_bf16_f32 v127, v82, v84
    ds_write_b128 v235, v[124:127] offset:29376
    s_cmp_lg_u32 s42, 0
    s_cbranch_scc1 L_k_wait
    s_mov_b32 s64, 0
L_kpoll_4:
    global_load_dwordx4 v[176:179], v252, s[40:41] sc1
    global_load_dwordx4 v[180:183], v253, s[40:41] sc1
    s_waitcnt vmcnt(0)
    v_xor_b32 v32, s44, v177
    v_xor_b32 v33, s44, v179
    v_xor_b32 v34, s44, v181
    v_xor_b32 v35, s44, v183
    v_or3_b32 v32, v32, v34, v35
    v_or_b32 v32, v32, v33
    v_cmp_ne_u32 vcc, 0, v32
    s_add_u32 s64, s64, 1
    s_cmp_eq_u64 vcc, 0
    s_cbranch_scc1 L_kpoll_4_done
    s_sleep 6
    s_cmp_lt_u32 s64, 40000
    s_cbranch_scc1 L_kpoll_4
L_kpoll_4_done:
L_k_wait:
    s_barrier
    global_load_dwordx2 v[144:145], v237, s[68:69] offset:0 sc1
    global_load_dwordx2 v[146:147], v237, s[68:69] offset:2048 sc1
    global_load_dwordx2 v[148:149], v239, s[68:69] offset:0 sc1
    global_load_dwordx2 v[150:151], v239, s[68:69] offset:2048 sc1
    global_load_dwordx4 v[160:163], v248, s[40:41] sc1
    global_load_dwordx4 v[164:167], v249, s[40:41] sc1
    global_load_dwordx4 v[168:171], v250, s[40:41] sc1
    global_load_dwordx4 v[172:175], v251, s[40:41] sc1
    s_cmp_lg_u32 s42, 0
    s_cbranch_scc1 L_k_not0
    v_max_u32 v45, v178, v182
    v_med3_u32 v178, v176, v180, v45
    v_max_u32 v176, v176, v180
    v_mov_b32 v240, v176
    v_mov_b32 v241, v178
    s_nop 1
    v_mov_b32_dpp v44, v240 quad_perm:[1,0,3,2] row_mask:0xf bank_mask:0xf
    v_max_u32_dpp v45, v241, v241 quad_perm:[1,0,3,2] row_mask:0xf bank_mask:0xf
    v_med3_u32 v241, v240, v44, v45
    v_max_u32 v240, v240, v44
    s_nop 1
    v_mov_b32_dpp v44, v240 quad_perm:[2,3,0,1] row_mask:0xf bank_mask:0xf
    v_max_u32_dpp v45, v241, v241 quad_perm:[2,3,0,1] row_mask:0xf bank_mask:0xf
    v_med3_u32 v241, v240, v44, v45
    v_max_u32 v240, v240, v44
    s_nop 1
    v_mov_b32_dpp v44, v240 row_half_mirror row_mask:0xf bank_mask:0xf
    v_max_u32_dpp v45, v241, v241 row_half_mirror row_mask:0xf bank_mask:0xf
    v_med3_u32 v241, v240, v44, v45
    v_max_u32 v240, v240, v44
    s_nop 1
    v_mov_b32_dpp v44, v240 row_mirror row_mask:0xf bank_mask:0xf
    v_max_u32_dpp v45, v241, v241 row_mirror row_mask:0xf bank_mask:0xf
    v_med3_u32 v241, v240, v44, v45
    v_max_u32 v240, v240, v44
    v_mov_b32 v44, v240
    v_mov_b32 v45, v241
    s_nop 1
    v_permlane16_swap_b32 v240, v44
    v_permlane16_swap_b32 v241, v45
    s_nop 0
    v_max_u32 v45, v241, v45
    v_med3_u32 v241, v240, v44, v45
    v_max_u32 v240, v240, v44
    v_mov_b32 v44, v240
    v_mov_b32 v45, v241
    s_nop 1
    v_permlane32_swap_b32 v240, v44
    v_permlane32_swap_b32 v241, v45
    s_nop 0
    v_max_u32 v45, v241, v45
    v_med3_u32 v241, v240, v44, v45
    v_max_u32 v240, v240, v44
    s_nop 0
    v_readfirstlane_b32 s72, v240
    v_readfirstlane_b32 s73, v241
    ds_write_b64 v2, v[240:241] offset:16
L_k_not0:
    s_waitcnt vmcnt(7)
    ds_write_b64 v237, v[144:145] offset:42752
    s_waitcnt vmcnt(6)
    ds_write_b64 v237, v[146:147] offset:44800
    s_waitcnt vmcnt(5)
    ds_write_b64 v237, v[148:149] offset:46848
    s_waitcnt vmcnt(4)
    ds_write_b64 v237, v[150:151] offset:48896
    v_lshlrev_b32 v50, 16, v144
    v_and_b32 v51, s74, v144
    v_lshlrev_b32 v56, 16, v145
    v_and_b32 v57, s74, v145
    v_lshlrev_b32 v62, 16, v146
    v_and_b32 v63, s74, v146
    v_lshlrev_b32 v68, 16, v147
    v_and_b32 v69, s74, v147
    v_lshlrev_b32 v74, 16, v148
    v_and_b32 v75, s74, v148
    v_lshlrev_b32 v80, 16, v149
    v_and_b32 v81, s74, v149
    v_lshlrev_b32 v86, 16, v150
    v_and_b32 v87, s74, v150
    v_lshlrev_b32 v92, 16, v151
    v_and_b32 v93, s74, v151
    s_mov_b32 s64, 0
    s_waitcnt vmcnt(0)
    s_branch L_sweep_5_chk
L_sweep_5:
    global_load_dwordx4 v[160:163], v248, s[40:41] sc1
    global_load_dwordx4 v[164:167], v249, s[40:41] sc1
    global_load_dwordx4 v[168:171], v250, s[40:41] sc1
    global_load_dwordx4 v[172:175], v251, s[40:41] sc1
    s_waitcnt vmcnt(0)
L_sweep_5_chk:
    v_xor_b32 v40, s44, v161
    v_xor_b32 v41, s44, v163
    v_xor_b32 v42, s44, v165
    v_xor_b32 v43, s44, v167
    v_or3_b32 v40, v40, v42, v43
    v_xor_b32 v42, s44, v169
    v_xor_b32 v43, s44, v171
    v_or3_b32 v40, v40, v42, v43
    v_xor_b32 v42, s44, v173
    v_xor_b32 v43, s44, v175
    v_or3_b32 v40, v40, v42, v43
    v_or_b32 v40, v40, v41
    v_cmp_ne_u32 vcc, 0, v40
    s_add_u32 s64, s64, 1
    s_cmp_eq_u64 vcc, 0
    s_cbranch_scc1 L_sweep_5_done
    s_sleep 4
    s_cmp_lt_u32 s64, 40000
    s_cbranch_scc1 L_sweep_5
L_sweep_5_done:
    v_and_b32 v128, s74, v160
    v_lshlrev_b32 v48, 16, v160
    v_rcp_f32 v128, v128
    v_and_b32 v130, s74, v162
    v_lshlrev_b32 v54, 16, v162
    v_rcp_f32 v130, v130
    v_and_b32 v132, s74, v164
    v_lshlrev_b32 v60, 16, v164
    v_rcp_f32 v132, v132
    v_and_b32 v134, s74, v166
    v_lshlrev_b32 v66, 16, v166
    v_rcp_f32 v134, v134
    v_and_b32 v136, s74, v168
    v_lshlrev_b32 v72, 16, v168
    v_rcp_f32 v136, v136
    v_and_b32 v138, s74, v170
    v_lshlrev_b32 v78, 16, v170
    v_rcp_f32 v138, v138
    v_and_b32 v140, s74, v172
    v_lshlrev_b32 v84, 16, v172
    v_rcp_f32 v140, v140
    v_and_b32 v142, s74, v174
    v_lshlrev_b32 v90, 16, v174
    v_rcp_f32 v142, v142
    v_pk_add_f32 v[50:51], v[50:51], v[48:49] op_sel_hi:[1,0] neg_lo:[0,1] neg_hi:[0,1]
    v_pk_add_f32 v[56:57], v[56:57], v[54:55] op_sel_hi:[1,0] neg_lo:[0,1] neg_hi:[0,1]
    v_pk_add_f32 v[62:63], v[62:63], v[60:61] op_sel_hi:[1,0] neg_lo:[0,1] neg_hi:[0,1]
    v_pk_add_f32 v[68:69], v[68:69], v[66:67] op_sel_hi:[1,0] neg_lo:[0,1] neg_hi:[0,1]
    v_pk_add_f32 v[74:75], v[74:75], v[72:73] op_sel_hi:[1,0] neg_lo:[0,1] neg_hi:[0,1]
    v_pk_add_f32 v[80:81], v[80:81], v[78:79] op_sel_hi:[1,0] neg_lo:[0,1] neg_hi:[0,1]
    v_pk_add_f32 v[86:87], v[86:87], v[84:85] op_sel_hi:[1,0] neg_lo:[0,1] neg_hi:[0,1]
    v_pk_add_f32 v[92:93], v[92:93], v[90:91] op_sel_hi:[1,0] neg_lo:[0,1] neg_hi:[0,1]
    v_cvt_pk_bf16_f32 v52, v50, v51
    v_cvt_pk_bf16_f32 v58, v56, v57
    v_cvt_pk_bf16_f32 v64, v62, v63
    v_cvt_pk_bf16_f32 v70, v68, v69
    v_cvt_pk_bf16_f32 v76, v74, v75
    v_cvt_pk_bf16_f32 v82, v80, v81
    v_cvt_pk_bf16_f32 v88, v86, v87
    v_cvt_pk_bf16_f32 v94, v92, v93
    v_lshlrev_b32 v50, 16, v52
    v_and_b32 v51, s74, v52
    v_lshlrev_b32 v56, 16, v58
    v_and_b32 v57, s74, v58
    v_lshlrev_b32 v62, 16, v64
    v_and_b32 v63, s74, v64
    v_lshlrev_b32 v68, 16, v70
    v_and_b32 v69, s74, v70
    v_lshlrev_b32 v74, 16, v76
    v_and_b32 v75, s74, v76
    v_lshlrev_b32 v80, 16, v82
    v_and_b32 v81, s74, v82
    v_lshlrev_b32 v86, 16, v88
    v_and_b32 v87, s74, v88
    v_lshlrev_b32 v92, 16, v94
    v_and_b32 v93, s74, v94
    v_pk_mul_f32 v[50:51], v[50:51], v[128:129] op_sel_hi:[1,0]
    v_pk_mul_f32 v[56:57], v[56:57], v[130:131] op_sel_hi:[1,0]
    v_pk_mul_f32 v[62:63], v[62:63], v[132:133] op_sel_hi:[1,0]
    v_pk_mul_f32 v[68:69], v[68:69], v[134:135] op_sel_hi:[1,0]
    v_pk_mul_f32 v[74:75], v[74:75], v[136:137] op_sel_hi:[1,0]
    v_pk_mul_f32 v[80:81], v[80:81], v[138:139] op_sel_hi:[1,0]
    v_pk_mul_f32 v[86:87], v[86:87], v[140:141] op_sel_hi:[1,0]
    v_pk_mul_f32 v[92:93], v[92:93], v[142:143] op_sel_hi:[1,0]
    v_cvt_pk_bf16_f32 v144, v50, v56
    ds_write_b32 v238, v144 offset:34048
    v_cvt_pk_bf16_f32 v145, v51, v57
    ds_write_b32 v238, v145 offset:38656
    v_cvt_pk_bf16_f32 v146, v62, v68
    ds_write_b32 v238, v146 offset:35072
    v_cvt_pk_bf16_f32 v147, v63, v69
    ds_write_b32 v238, v147 offset:39680
    v_cvt_pk_bf16_f32 v148, v74, v80
    ds_write_b32 v238, v148 offset:36096
    v_cvt_pk_bf16_f32 v149, v75, v81
    ds_write_b32 v238, v149 offset:40704
    v_cvt_pk_bf16_f32 v150, v86, v92
    ds_write_b32 v238, v150 offset:37120
    v_cvt_pk_bf16_f32 v151, v87, v93
    ds_write_b32 v238, v151 offset:41728
    s_waitcnt lgkmcnt(0)
    s_barrier
    ds_read_b64 v[24:25], v2 offset:16
    ds_read_b128 v[160:163], v227 offset:192
    ds_read_b128 v[164:167], v227 offset:704
    ds_read_b64 v[32:33], v226 offset:4032
    ds_read_b64 v[34:35], v226 offset:4040
    ds_read_b64 v[36:37], v226 offset:3520
    ds_read_b64 v[38:39], v226 offset:3528
    ds_read_b128 v[168:171], v227 offset:128
    ds_read_b128 v[172:175], v227 offset:640
    ds_read_b64 v[64:65], v226 offset:3968
    ds_read_b64 v[66:67], v226 offset:3976
    ds_read_b64 v[68:69], v226 offset:3456
    ds_read_b64 v[70:71], v226 offset:3464
    ds_read_b128 v[176:179], v227 offset:64
    ds_read_b128 v[180:183], v227 offset:576
    ds_read_b64 v[96:97], v226 offset:3904
    ds_read_b64 v[98:99], v226 offset:3912
    ds_read_b64 v[100:101], v226 offset:3392
    ds_read_b64 v[102:103], v226 offset:3400
    ds_read_b128 v[184:187], v227 offset:0
    ds_read_b128 v[188:191], v227 offset:512
    ds_read_b64 v[128:129], v226 offset:3840
    ds_read_b64 v[130:131], v226 offset:3848
    ds_read_b64 v[132:133], v226 offset:3328
    ds_read_b64 v[134:135], v226 offset:3336
    s_waitcnt lgkmcnt(15)
    v_readfirstlane_b32 s72, v24
    v_readfirstlane_b32 s73, v25
    s_and_b32 s48, s72, 0xffff
    s_sub_u32 s52, 0xffff, s48
    s_bfe_u32 s49, s52, 0x10008
    s_lshl_b32 s49, s49, 1
    s_bfe_u32 s50, s52, 0x10001
    s_or_b32 s49, s49, s50
    s_cmp_eq_u32 s49, s42
    s_cselect_b32 s54, 1, 0
    s_cmp_lt_u32 s52, 2048
    s_cselect_b32 s54, s54, 0
    s_and_b32 s48, s73, 0xffff
    s_sub_u32 s53, 0xffff, s48
    s_bfe_u32 s49, s53, 0x10008
    s_lshl_b32 s49, s49, 1
    s_bfe_u32 s50, s53, 0x10001
    s_or_b32 s49, s49, s50
    s_cmp_eq_u32 s49, s42
    s_cselect_b32 s55, 1, 0
    s_cmp_lt_u32 s53, 2048
    s_cselect_b32 s55, s55, 0
    s_waitcnt lgkmcnt(15)
    v_mfma_f32_16x16x32_bf16 v[8:11], v[32:35], v[160:163], 0
    ds_read_b128 v[192:195], v227 offset:192
    ds_read_b128 v[196:199], v227 offset:704
    v_mfma_f32_16x16x32_bf16 v[12:15], v[32:35], v[164:167], 0
    ds_read_b64 v[40:41], v226 offset:3008
    ds_read_b64 v[42:43], v226 offset:3016
    v_mfma_f32_16x16x32_bf16 v[12:15], v[36:39], v[160:163], v[12:15]
    ds_read_b64 v[44:45], v226 offset:2496
    ds_read_b64 v[46:47], v226 offset:2504
    s_waitcnt lgkmcnt(15)
    v_mfma_f32_16x16x32_bf16 v[8:11], v[64:67], v[168:171], v[8:11]
    ds_read_b128 v[200:203], v227 offset:1216
    ds_read_b128 v[204:207], v227 offset:1728
    v_mfma_f32_16x16x32_bf16 v[12:15], v[64:67], v[172:175], v[12:15]
    ds_read_b128 v[208:211], v227 offset:128
    ds_read_b128 v[212:215], v227 offset:640
    v_mfma_f32_16x16x32_bf16 v[12:15], v[68:71], v[168:171], v[12:15]
    ds_read_b64 v[72:73], v226 offset:2944
    ds_read_b64 v[74:75], v226 offset:2952
    s_waitcnt lgkmcnt(15)
    v_mfma_f32_16x16x32_bf16 v[8:11], v[96:99], v[176:179], v[8:11]
    ds_read_b64 v[76:77], v226 offset:2432
    ds_read_b64 v[78:79], v226 offset:2440
    v_mfma_f32_16x16x32_bf16 v[12:15], v[96:99], v[180:183], v[12:15]
    ds_read_b128 v[216:219], v227 offset:1152
    ds_read_b128 v[220:223], v227 offset:1664
    v_mfma_f32_16x16x32_bf16 v[12:15], v[100:103], v[176:179], v[12:15]
    s_waitcnt lgkmcnt(15)
    v_mfma_f32_16x16x32_bf16 v[8:11], v[128:131], v[184:187], v[8:11]
    v_mfma_f32_16x16x32_bf16 v[12:15], v[128:131], v[188:191], v[12:15]
    v_mfma_f32_16x16x32_bf16 v[12:15], v[132:135], v[184:187], v[12:15]
    s_nop 7
    ds_write_b128 v228, v[8:11] offset:50944
    ds_write_b128 v228, v[12:15] offset:51968
    s_waitcnt lgkmcnt(0)
    s_barrier
    ds_read_b64 v[248:249], v229 offset:50944
    ds_read_b64 v[250:251], v229 offset:52992
    ds_read_b64 v[252:253], v229 offset:55040
    ds_read_b64 v[254:255], v229 offset:57088
    ds_read_b64 v[24:25], v242 offset:42752
    ds_read_b32 v26, v243 offset:34048
    ds_read_b32 v27, v243 offset:38656
    v_mfma_f32_16x16x32_bf16 v[16:19], v[36:39], v[196:199], 0
    ds_read_b128 v[160:163], v227 offset:64
    ds_read_b128 v[164:167], v227 offset:576
    v_mfma_f32_16x16x32_bf16 v[16:19], v[32:35], v[200:203], v[16:19]
    ds_read_b64 v[104:105], v226 offset:2880
    ds_read_b64 v[106:107], v226 offset:2888
    v_mfma_f32_16x16x32_bf16 v[16:19], v[40:43], v[192:195], v[16:19]
    ds_read_b64 v[108:109], v226 offset:2368
    ds_read_b64 v[110:111], v226 offset:2376
    s_waitcnt lgkmcnt(6)
    v_mfma_f32_16x16x32_bf16 v[20:23], v[36:39], v[200:203], 0
    ds_read_b128 v[168:171], v227 offset:1088
    ds_read_b128 v[172:175], v227 offset:1600
    v_pk_add_f32 v[248:249], v[248:249], v[250:251]
    v_pk_add_f32 v[252:253], v[252:253], v[254:255]
    v_lshlrev_b32 v28, 16, v24
    v_mfma_f32_16x16x32_bf16 v[20:23], v[40:43], v[196:199], v[20:23]
    ds_read_b128 v[176:179], v227 offset:0
    ds_read_b128 v[180:183], v227 offset:512
    v_and_b32 v29, s74, v24
    v_lshlrev_b32 v30, 16, v26
    v_lshlrev_b32 v31, 16, v27
    v_mfma_f32_16x16x32_bf16 v[20:23], v[32:35], v[204:207], v[20:23]
    ds_read_b64 v[136:137], v226 offset:2816
    ds_read_b64 v[138:139], v226 offset:2824
    v_add_f32 v28, v28, v248
    v_add_f32 v29, v29, v252
    v_pk_fma_f32 v[28:29], v[30:31], s[60:61], v[28:29]
    v_mfma_f32_16x16x32_bf16 v[20:23], v[44:47], v[192:195], v[20:23]
    ds_read_b64 v[140:141], v226 offset:2304
    ds_read_b64 v[142:143], v226 offset:2312
    v_cvt_pk_bf16_f32 v24, v28, v29
    s_sub_u32 s48, s52, 0
    s_sub_u32 s49, s53, 0
    v_mfma_f32_16x16x32_bf16 v[16:19], v[68:71], v[212:215], v[16:19]
    ds_read_b128 v[184:187], v227 offset:1024
    ds_read_b128 v[188:191], v227 offset:1536
    v_cmp_ne_u32 vcc, s48, v230
    v_cmp_ne_u32 s[50:51], s49, v230
    s_and_b64 exec, vcc, s[50:51]
    global_store_dword v232, v24, s[36:37] offset:0
    s_mov_b64 exec, -1
    v_mfma_f32_16x16x32_bf16 v[16:19], v[64:67], v[216:219], v[16:19]
    v_lshlrev_b32 v250, 16, v25
    v_and_b32 v251, s74, v25
    v_and_b32 v254, s74, v26
    v_mfma_f32_16x16x32_bf16 v[16:19], v[72:75], v[208:211], v[16:19]
    v_and_b32 v255, s74, v27
    v_add_f32 v250, v250, v249
    v_add_f32 v251, v251, v253
    v_mfma_f32_16x16x32_bf16 v[20:23], v[68:71], v[216:219], v[20:23]
    v_pk_fma_f32 v[250:251], v[254:255], s[60:61], v[250:251]
    v_cvt_pk_bf16_f32 v25, v250, v251
    s_sub_u32 s48, s52, 1
    v_mfma_f32_16x16x32_bf16 v[20:23], v[72:75], v[212:215], v[20:23]
    s_sub_u32 s49, s53, 1
    v_cmp_ne_u32 vcc, s48, v230
    v_cmp_ne_u32 s[50:51], s49, v230
    v_mfma_f32_16x16x32_bf16 v[20:23], v[64:67], v[220:223], v[20:23]
    s_and_b64 exec, vcc, s[50:51]
    global_store_dword v232, v25, s[36:37] offset:1024
    s_mov_b64 exec, -1
    ds_write_b64 v242, v[24:25] offset:42752
    v_add_u32 v232, 0x80000, v232
    v_mfma_f32_16x16x32_bf16 v[20:23], v[76:79], v[208:211], v[20:23]
    s_waitcnt lgkmcnt(0)
    v_mfma_f32_16x16x32_bf16 v[16:19], v[100:103], v[164:167], v[16:19]
    ds_read_b128 v[192:195], v227 offset:192
    v_mfma_f32_16x16x32_bf16 v[16:19], v[96:99], v[168:171], v[16:19]
    ds_read_b128 v[196:199], v227 offset:704
    v_mfma_f32_16x16x32_bf16 v[16:19], v[104:107], v[160:163], v[16:19]
    ds_read_b64 v[48:49], v226 offset:1984
    v_mfma_f32_16x16x32_bf16 v[20:23], v[100:103], v[168:171], v[20:23]
    ds_read_b64 v[50:51], v226 offset:1992
    v_mfma_f32_16x16x32_bf16 v[20:23], v[104:107], v[164:167], v[20:23]
    ds_read_b64 v[52:53], v226 offset:1472
    v_mfma_f32_16x16x32_bf16 v[20:23], v[96:99], v[172:175], v[20:23]
    ds_read_b64 v[54:55], v226 offset:1480
    v_mfma_f32_16x16x32_bf16 v[20:23], v[108:111], v[160:163], v[20:23]
    ds_read_b128 v[200:203], v227 offset:1216
    v_mfma_f32_16x16x32_bf16 v[16:19], v[132:135], v[180:183], v[16:19]
    ds_read_b128 v[204:207], v227 offset:1728
    v_mfma_f32_16x16x32_bf16 v[16:19], v[128:131], v[184:187], v[16:19]
    ds_read_b128 v[208:211], v227 offset:2240
    v_mfma_f32_16x16x32_bf16 v[16:19], v[136:139], v[176:179], v[16:19]
    ds_read_b128 v[212:215], v227 offset:2752
    v_mfma_f32_16x16x32_bf16 v[20:23], v[132:135], v[184:187], v[20:23]
    v_mfma_f32_16x16x32_bf16 v[20:23], v[136:139], v[180:183], v[20:23]
    v_mfma_f32_16x16x32_bf16 v[20:23], v[128:131], v[188:191], v[20:23]
    v_mfma_f32_16x16x32_bf16 v[20:23], v[140:143], v[176:179], v[20:23]
    s_nop 7
    ds_write_b128 v228, v[16:19] offset:59136
    ds_write_b128 v228, v[20:23] offset:60160
    s_waitcnt lgkmcnt(0)
    s_barrier
    ds_read_b64 v[248:249], v229 offset:59136
    ds_read_b64 v[250:251], v229 offset:61184
    ds_read_b64 v[252:253], v229 offset:63232
    ds_read_b64 v[254:255], v229 offset:65280
    ds_read_b64 v[24:25], v242 offset:44800
    ds_read_b32 v26, v243 offset:35072
    ds_read_b32 v27, v243 offset:39680
    v_mfma_f32_16x16x32_bf16 v[8:11], v[44:47], v[196:199], 0
    ds_read_b128 v[160:163], v227 offset:128
    v_mfma_f32_16x16x32_bf16 v[8:11], v[40:43], v[200:203], v[8:11]
    ds_read_b128 v[164:167], v227 offset:640
    v_mfma_f32_16x16x32_bf16 v[12:15], v[44:47], v[200:203], 0
    ds_read_b64 v[80:81], v226 offset:1920
    s_waitcnt lgkmcnt(3)
    v_mfma_f32_16x16x32_bf16 v[8:11], v[36:39], v[204:207], v[8:11]
    ds_read_b64 v[82:83], v226 offset:1928
    v_pk_add_f32 v[248:249], v[248:249], v[250:251]
    v_pk_add_f32 v[252:253], v[252:253], v[254:255]
    v_lshlrev_b32 v28, 16, v24
    v_and_b32 v29, s74, v24
    v_mfma_f32_16x16x32_bf16 v[12:15], v[40:43], v[204:207], v[12:15]
    ds_read_b64 v[84:85], v226 offset:1408
    v_lshlrev_b32 v30, 16, v26
    v_lshlrev_b32 v31, 16, v27
    v_add_f32 v28, v28, v248
    v_add_f32 v29, v29, v252
    v_mfma_f32_16x16x32_bf16 v[8:11], v[32:35], v[208:211], v[8:11]
    ds_read_b64 v[86:87], v226 offset:1416
    v_pk_fma_f32 v[28:29], v[30:31], s[60:61], v[28:29]
    v_cvt_pk_bf16_f32 v24, v28, v29
    s_sub_u32 s48, s52, 512
    s_sub_u32 s49, s53, 512
    v_mfma_f32_16x16x32_bf16 v[8:11], v[48:51], v[192:195], v[8:11]
    ds_read_b128 v[168:171], v227 offset:1152
    v_cmp_ne_u32 vcc, s48, v230
    v_cmp_ne_u32 s[50:51], s49, v230
    s_and_b64 exec, vcc, s[50:51]
    global_store_dword v232, v24, s[36:37] offset:0
    s_mov_b64 exec, -1
    v_lshlrev_b32 v250, 16, v25
    v_mfma_f32_16x16x32_bf16 v[12:15], v[36:39], v[208:211], v[12:15]
    ds_read_b128 v[172:175], v227 offset:1664
    v_and_b32 v251, s74, v25
    v_and_b32 v254, s74, v26
    v_and_b32 v255, s74, v27
    v_add_f32 v250, v250, v249
    v_mfma_f32_16x16x32_bf16 v[12:15], v[48:51], v[196:199], v[12:15]
    ds_read_b128 v[176:179], v227 offset:2176
    v_add_f32 v251, v251, v253
    v_pk_fma_f32 v[250:251], v[254:255], s[60:61], v[250:251]
    v_cvt_pk_bf16_f32 v25, v250, v251
    s_sub_u32 s48, s52, 513
    v_mfma_f32_16x16x32_bf16 v[12:15], v[32:35], v[212:215], v[12:15]
    ds_read_b128 v[180:183], v227 offset:2688
    s_sub_u32 s49, s53, 513
    v_cmp_ne_u32 vcc, s48, v230
    v_cmp_ne_u32 s[50:51], s49, v230
    s_and_b64 exec, vcc, s[50:51]
    global_store_dword v232, v25, s[36:37] offset:1024
    s_mov_b64 exec, -1
    v_mfma_f32_16x16x32_bf16 v[12:15], v[52:55], v[192:195], v[12:15]
    ds_write_b64 v242, v[24:25] offset:44800
    v_add_u32 v232, 0x80000, v232
    s_waitcnt lgkmcnt(0)
    v_mfma_f32_16x16x32_bf16 v[8:11], v[76:79], v[164:167], v[8:11]
    ds_read_b128 v[192:195], v227 offset:64
    v_mfma_f32_16x16x32_bf16 v[8:11], v[72:75], v[168:171], v[8:11]
    ds_read_b128 v[196:199], v227 offset:576
    v_mfma_f32_16x16x32_bf16 v[12:15], v[76:79], v[168:171], v[12:15]
    ds_read_b64 v[112:113], v226 offset:1856
    v_mfma_f32_16x16x32_bf16 v[8:11], v[68:71], v[172:175], v[8:11]
    ds_read_b64 v[114:115], v226 offset:1864
    v_mfma_f32_16x16x32_bf16 v[12:15], v[72:75], v[172:175], v[12:15]
    ds_read_b64 v[116:117], v226 offset:1344
    v_mfma_f32_16x16x32_bf16 v[8:11], v[64:67], v[176:179], v[8:11]
    ds_read_b64 v[118:119], v226 offset:1352
    v_mfma_f32_16x16x32_bf16 v[8:11], v[80:83], v[160:163], v[8:11]
    ds_read_b128 v[200:203], v227 offset:1088
    v_mfma_f32_16x16x32_bf16 v[12:15], v[68:71], v[176:179], v[12:15]
    ds_read_b128 v[204:207], v227 offset:1600
    v_mfma_f32_16x16x32_bf16 v[12:15], v[80:83], v[164:167], v[12:15]
    ds_read_b128 v[208:211], v227 offset:2112
    v_mfma_f32_16x16x32_bf16 v[12:15], v[64:67], v[180:183], v[12:15]
    ds_read_b128 v[212:215], v227 offset:2624
    v_mfma_f32_16x16x32_bf16 v[12:15], v[84:87], v[160:163], v[12:15]
    s_waitcnt lgkmcnt(0)
    v_mfma_f32_16x16x32_bf16 v[8:11], v[108:111], v[196:199], v[8:11]
    ds_read_b128 v[160:163], v227 offset:0
    v_mfma_f32_16x16x32_bf16 v[8:11], v[104:107], v[200:203], v[8:11]
    ds_read_b128 v[164:167], v227 offset:512
    v_mfma_f32_16x16x32_bf16 v[12:15], v[108:111], v[200:203], v[12:15]
    ds_read_b64 v[144:145], v226 offset:1792
    v_mfma_f32_16x16x32_bf16 v[8:11], v[100:103], v[204:207], v[8:11]
    ds_read_b64 v[146:147], v226 offset:1800
    v_mfma_f32_16x16x32_bf16 v[12:15], v[104:107], v[204:207], v[12:15]
    ds_read_b64 v[148:149], v226 offset:1280
    v_mfma_f32_16x16x32_bf16 v[8:11], v[96:99], v[208:211], v[8:11]
    ds_read_b64 v[150:151], v226 offset:1288
    v_mfma_f32_16x16x32_bf16 v[8:11], v[112:115], v[192:195], v[8:11]
    ds_read_b128 v[168:171], v227 offset:1024
    v_mfma_f32_16x16x32_bf16 v[12:15], v[100:103], v[208:211], v[12:15]
    ds_read_b128 v[172:175], v227 offset:1536
    v_mfma_f32_16x16x32_bf16 v[12:15], v[112:115], v[196:199], v[12:15]
    ds_read_b128 v[176:179], v227 offset:2048
    v_mfma_f32_16x16x32_bf16 v[12:15], v[96:99], v[212:215], v[12:15]
    ds_read_b128 v[180:183], v227 offset:2560
    v_mfma_f32_16x16x32_bf16 v[12:15], v[116:119], v[192:195], v[12:15]
    s_waitcnt lgkmcnt(0)
    v_mfma_f32_16x16x32_bf16 v[8:11], v[140:143], v[164:167], v[8:11]
    ds_read_b128 v[192:195], v227 offset:192
    ds_read_b128 v[196:199], v227 offset:704
    v_mfma_f32_16x16x32_bf16 v[8:11], v[136:139], v[168:171], v[8:11]
    ds_read_b64 v[56:57], v226 offset:960
    ds_read_b64 v[58:59], v226 offset:968
    v_mfma_f32_16x16x32_bf16 v[12:15], v[140:143], v[168:171], v[12:15]
    ds_read_b64 v[60:61], v226 offset:448
    ds_read_b64 v[62:63], v226 offset:456
    v_mfma_f32_16x16x32_bf16 v[8:11], v[132:135], v[172:175], v[8:11]
    ds_read_b128 v[200:203], v227 offset:1216
    ds_read_b128 v[204:207], v227 offset:1728
    v_mfma_f32_16x16x32_bf16 v[12:15], v[136:139], v[172:175], v[12:15]
    ds_read_b128 v[208:211], v227 offset:2240
    ds_read_b128 v[212:215], v227 offset:2752
    v_mfma_f32_16x16x32_bf16 v[8:11], v[128:131], v[176:179], v[8:11]
    ds_read_b128 v[216:219], v227 offset:3264
    ds_read_b128 v[220:223], v227 offset:3776
    v_mfma_f32_16x16x32_bf16 v[8:11], v[144:147], v[160:163], v[8:11]
    v_mfma_f32_16x16x32_bf16 v[12:15], v[132:135], v[176:179], v[12:15]
    v_mfma_f32_16x16x32_bf16 v[12:15], v[144:147], v[164:167], v[12:15]
    v_mfma_f32_16x16x32_bf16 v[12:15], v[128:131], v[180:183], v[12:15]
    v_mfma_f32_16x16x32_bf16 v[12:15], v[148:151], v[160:163], v[12:15]
    s_nop 7
    ds_write_b128 v228, v[8:11] offset:50944
    ds_write_b128 v228, v[12:15] offset:51968
    s_waitcnt lgkmcnt(0)
    s_barrier
    ds_read_b64 v[248:249], v229 offset:50944
    ds_read_b64 v[250:251], v229 offset:52992
    ds_read_b64 v[252:253], v229 offset:55040
    ds_read_b64 v[254:255], v229 offset:57088
    ds_read_b64 v[24:25], v242 offset:46848
    ds_read_b32 v26, v243 offset:36096
    ds_read_b32 v27, v243 offset:40704
    v_mfma_f32_16x16x32_bf16 v[16:19], v[52:55], v[196:199], 0
    ds_read_b128 v[160:163], v227 offset:128
    v_mfma_f32_16x16x32_bf16 v[16:19], v[48:51], v[200:203], v[16:19]
    ds_read_b128 v[164:167], v227 offset:640
    v_mfma_f32_16x16x32_bf16 v[20:23], v[52:55], v[200:203], 0
    ds_read_b64 v[88:89], v226 offset:896
    s_waitcnt lgkmcnt(3)
    v_mfma_f32_16x16x32_bf16 v[16:19], v[44:47], v[204:207], v[16:19]
    ds_read_b64 v[90:91], v226 offset:904
    v_pk_add_f32 v[248:249], v[248:249], v[250:251]
    v_pk_add_f32 v[252:253], v[252:253], v[254:255]
    v_lshlrev_b32 v28, 16, v24
    v_mfma_f32_16x16x32_bf16 v[20:23], v[48:51], v[204:207], v[20:23]
    ds_read_b64 v[92:93], v226 offset:384
    v_and_b32 v29, s74, v24
    v_lshlrev_b32 v30, 16, v26
    v_lshlrev_b32 v31, 16, v27
    v_mfma_f32_16x16x32_bf16 v[16:19], v[40:43], v[208:211], v[16:19]
    ds_read_b64 v[94:95], v226 offset:392
    v_add_f32 v28, v28, v248
    v_add_f32 v29, v29, v252
    v_pk_fma_f32 v[28:29], v[30:31], s[60:61], v[28:29]
    v_mfma_f32_16x16x32_bf16 v[20:23], v[44:47], v[208:211], v[20:23]
    ds_read_b128 v[168:171], v227 offset:1152
    v_cvt_pk_bf16_f32 v24, v28, v29
    s_sub_u32 s48, s52, 1024
    s_sub_u32 s49, s53, 1024
    v_mfma_f32_16x16x32_bf16 v[16:19], v[36:39], v[212:215], v[16:19]
    ds_read_b128 v[172:175], v227 offset:1664
    v_cmp_ne_u32 vcc, s48, v230
    v_cmp_ne_u32 s[50:51], s49, v230
    s_and_b64 exec, vcc, s[50:51]
    global_store_dword v232, v24, s[36:37] offset:0
    s_mov_b64 exec, -1
    v_mfma_f32_16x16x32_bf16 v[20:23], v[40:43], v[212:215], v[20:23]
    ds_read_b128 v[176:179], v227 offset:2176
    v_lshlrev_b32 v250, 16, v25
    v_and_b32 v251, s74, v25
    v_and_b32 v254, s74, v26
    v_mfma_f32_16x16x32_bf16 v[16:19], v[32:35], v[216:219], v[16:19]
    ds_read_b128 v[180:183], v227 offset:2688
    v_and_b32 v255, s74, v27
    v_add_f32 v250, v250, v249
    v_add_f32 v251, v251, v253
    v_mfma_f32_16x16x32_bf16 v[16:19], v[56:59], v[192:195], v[16:19]
    ds_read_b128 v[184:187], v227 offset:3200
    v_pk_fma_f32 v[250:251], v[254:255], s[60:61], v[250:251]
    v_cvt_pk_bf16_f32 v25, v250, v251
    s_sub_u32 s48, s52, 1025
    v_mfma_f32_16x16x32_bf16 v[20:23], v[36:39], v[216:219], v[20:23]
    ds_read_b128 v[188:191], v227 offset:3712
    s_sub_u32 s49, s53, 1025
    v_cmp_ne_u32 vcc, s48, v230
    v_cmp_ne_u32 s[50:51], s49, v230
    v_mfma_f32_16x16x32_bf16 v[20:23], v[56:59], v[196:199], v[20:23]
    s_and_b64 exec, vcc, s[50:51]
    global_store_dword v232, v25, s[36:37] offset:1024
    s_mov_b64 exec, -1
    ds_write_b64 v242, v[24:25] offset:46848
    v_add_u32 v232, 0x80000, v232
    v_mfma_f32_16x16x32_bf16 v[20:23], v[32:35], v[220:223], v[20:23]
    v_mfma_f32_16x16x32_bf16 v[20:23], v[60:63], v[192:195], v[20:23]
    s_waitcnt lgkmcnt(0)
    v_mfma_f32_16x16x32_bf16 v[16:19], v[84:87], v[164:167], v[16:19]
    ds_read_b128 v[192:195], v227 offset:64
    v_mfma_f32_16x16x32_bf16 v[16:19], v[80:83], v[168:171], v[16:19]
    ds_read_b128 v[196:199], v227 offset:576
    v_mfma_f32_16x16x32_bf16 v[20:23], v[84:87], v[168:171], v[20:23]
    ds_read_b64 v[120:121], v226 offset:832
    v_mfma_f32_16x16x32_bf16 v[16:19], v[76:79], v[172:175], v[16:19]
    ds_read_b64 v[122:123], v226 offset:840
    v_mfma_f32_16x16x32_bf16 v[20:23], v[80:83], v[172:175], v[20:23]
    ds_read_b64 v[124:125], v226 offset:320
    v_mfma_f32_16x16x32_bf16 v[16:19], v[72:75], v[176:179], v[16:19]
    ds_read_b64 v[126:127], v226 offset:328
    v_mfma_f32_16x16x32_bf16 v[20:23], v[76:79], v[176:179], v[20:23]
    ds_read_b128 v[200:203], v227 offset:1088
    v_mfma_f32_16x16x32_bf16 v[16:19], v[68:71], v[180:183], v[16:19]
    ds_read_b128 v[204:207], v227 offset:1600
    v_mfma_f32_16x16x32_bf16 v[20:23], v[72:75], v[180:183], v[20:23]
    ds_read_b128 v[208:211], v227 offset:2112
    v_mfma_f32_16x16x32_bf16 v[16:19], v[64:67], v[184:187], v[16:19]
    ds_read_b128 v[212:215], v227 offset:2624
    v_mfma_f32_16x16x32_bf16 v[16:19], v[88:91], v[160:163], v[16:19]
    ds_read_b128 v[216:219], v227 offset:3136
    v_mfma_f32_16x16x32_bf16 v[20:23], v[68:71], v[184:187], v[20:23]
    ds_read_b128 v[220:223], v227 offset:3648
    v_mfma_f32_16x16x32_bf16 v[20:23], v[88:91], v[164:167], v[20:23]
    v_mfma_f32_16x16x32_bf16 v[20:23], v[64:67], v[188:191], v[20:23]
    v_mfma_f32_16x16x32_bf16 v[20:23], v[92:95], v[160:163], v[20:23]
    s_waitcnt lgkmcnt(0)
    v_mfma_f32_16x16x32_bf16 v[16:19], v[116:119], v[196:199], v[16:19]
    ds_read_b128 v[160:163], v227 offset:0
    v_mfma_f32_16x16x32_bf16 v[16:19], v[112:115], v[200:203], v[16:19]
    ds_read_b128 v[164:167], v227 offset:512
    v_mfma_f32_16x16x32_bf16 v[20:23], v[116:119], v[200:203], v[20:23]
    ds_read_b64 v[152:153], v226 offset:768
    v_mfma_f32_16x16x32_bf16 v[16:19], v[108:111], v[204:207], v[16:19]
    ds_read_b64 v[154:155], v226 offset:776
    v_mfma_f32_16x16x32_bf16 v[20:23], v[112:115], v[204:207], v[20:23]
    ds_read_b64 v[156:157], v226 offset:256
    v_mfma_f32_16x16x32_bf16 v[16:19], v[104:107], v[208:211], v[16:19]
    ds_read_b64 v[158:159], v226 offset:264
    v_mfma_f32_16x16x32_bf16 v[20:23], v[108:111], v[208:211], v[20:23]
    ds_read_b128 v[168:171], v227 offset:1024
    v_mfma_f32_16x16x32_bf16 v[16:19], v[100:103], v[212:215], v[16:19]
    ds_read_b128 v[172:175], v227 offset:1536
    v_mfma_f32_16x16x32_bf16 v[20:23], v[104:107], v[212:215], v[20:23]
    ds_read_b128 v[176:179], v227 offset:2048
    v_mfma_f32_16x16x32_bf16 v[16:19], v[96:99], v[216:219], v[16:19]
    ds_read_b128 v[180:183], v227 offset:2560
    v_mfma_f32_16x16x32_bf16 v[16:19], v[120:123], v[192:195], v[16:19]
    ds_read_b128 v[184:187], v227 offset:3072
    v_mfma_f32_16x16x32_bf16 v[20:23], v[100:103], v[216:219], v[20:23]
    ds_read_b128 v[188:191], v227 offset:3584
    v_mfma_f32_16x16x32_bf16 v[20:23], v[120:123], v[196:199], v[20:23]
    v_mfma_f32_16x16x32_bf16 v[20:23], v[96:99], v[220:223], v[20:23]
    v_mfma_f32_16x16x32_bf16 v[20:23], v[124:127], v[192:195], v[20:23]
    s_cmp_eq_u32 s54, 0
    s_cbranch_scc1 L_np0
    s_lshl_b32 s49, s43, 4
    s_add_u32 s49, s49, 0
    v_lshl_add_u32 v208, v1, 12, s49
    v_add_u32 v209, 0x40000, v208
    v_mov_b32 v196, 0
    v_mov_b32 v197, s44
    v_mov_b32 v198, 0
    v_mov_b32 v199, s44
    global_load_dwordx4 v[192:195], v208, s[70:71] sc1
    s_bfm_b64 exec, 48, 0
    global_load_dwordx4 v[196:199], v209, s[70:71] sc1
    s_mov_b64 exec, -1
L_np0:
    s_cmp_eq_u32 s55, 0
    s_cbranch_scc1 L_np1
    s_lshl_b32 s49, s43, 4
    s_add_u32 s49, s49, 524288
    v_lshl_add_u32 v210, v1, 12, s49
    v_add_u32 v211, 0x40000, v210
    v_mov_b32 v204, 0
    v_mov_b32 v205, s44
    v_mov_b32 v206, 0
    v_mov_b32 v207, s44
    global_load_dwordx4 v[200:203], v210, s[70:71] sc1
    s_bfm_b64 exec, 48, 0
    global_load_dwordx4 v[204:207], v211, s[70:71] sc1
    s_mov_b64 exec, -1
L_np1:
    s_nop 3
    s_waitcnt lgkmcnt(0)
    v_mfma_f32_16x16x32_bf16 v[16:19], v[148:151], v[164:167], v[16:19]
    v_mfma_f32_16x16x32_bf16 v[16:19], v[144:147], v[168:171], v[16:19]
    v_mfma_f32_16x16x32_bf16 v[20:23], v[148:151], v[168:171], v[20:23]
    v_mfma_f32_16x16x32_bf16 v[16:19], v[140:143], v[172:175], v[16:19]
    v_mfma_f32_16x16x32_bf16 v[20:23], v[144:147], v[172:175], v[20:23]
    v_mfma_f32_16x16x32_bf16 v[16:19], v[136:139], v[176:179], v[16:19]
    v_mfma_f32_16x16x32_bf16 v[20:23], v[140:143], v[176:179], v[20:23]
    v_mfma_f32_16x16x32_bf16 v[16:19], v[132:135], v[180:183], v[16:19]
    v_mfma_f32_16x16x32_bf16 v[20:23], v[136:139], v[180:183], v[20:23]
    v_mfma_f32_16x16x32_bf16 v[16:19], v[128:131], v[184:187], v[16:19]
    v_mfma_f32_16x16x32_bf16 v[16:19], v[152:155], v[160:163], v[16:19]
    v_mfma_f32_16x16x32_bf16 v[20:23], v[132:135], v[184:187], v[20:23]
    v_mfma_f32_16x16x32_bf16 v[20:23], v[152:155], v[164:167], v[20:23]
    v_mfma_f32_16x16x32_bf16 v[20:23], v[128:131], v[188:191], v[20:23]
    v_mfma_f32_16x16x32_bf16 v[20:23], v[156:159], v[160:163], v[20:23]
    s_nop 7
    ds_write_b128 v228, v[16:19] offset:59136
    ds_write_b128 v228, v[20:23] offset:60160
    s_waitcnt lgkmcnt(0)
    s_barrier
    ds_read_b64 v[248:249], v229 offset:59136
    ds_read_b64 v[250:251], v229 offset:61184
    ds_read_b64 v[252:253], v229 offset:63232
    ds_read_b64 v[254:255], v229 offset:65280
    ds_read_b64 v[24:25], v242 offset:48896
    ds_read_b32 v26, v243 offset:37120
    ds_read_b32 v27, v243 offset:41728
    s_waitcnt lgkmcnt(0)
    v_pk_add_f32 v[248:249], v[248:249], v[250:251]
    v_pk_add_f32 v[252:253], v[252:253], v[254:255]
    v_lshlrev_b32 v28, 16, v24
    v_and_b32 v29, s74, v24
    v_lshlrev_b32 v30, 16, v26
    v_lshlrev_b32 v31, 16, v27
    v_add_f32 v28, v28, v248
    v_add_f32 v29, v29, v252
    v_pk_fma_f32 v[28:29], v[30:31], s[60:61], v[28:29]
    v_cvt_pk_bf16_f32 v24, v28, v29
    s_sub_u32 s48, s52, 1536
    s_sub_u32 s49, s53, 1536
    v_cmp_ne_u32 vcc, s48, v230
    v_cmp_ne_u32 s[50:51], s49, v230
    s_and_b64 exec, vcc, s[50:51]
    global_store_dword v232, v24, s[36:37] offset:0
    s_mov_b64 exec, -1
    v_lshlrev_b32 v250, 16, v25
    v_and_b32 v251, s74, v25
    v_and_b32 v254, s74, v26
    v_and_b32 v255, s74, v27
    v_add_f32 v250, v250, v249
    v_add_f32 v251, v251, v253
    v_pk_fma_f32 v[250:251], v[254:255], s[60:61], v[250:251]
    v_cvt_pk_bf16_f32 v25, v250, v251
    s_sub_u32 s48, s52, 1537
    s_sub_u32 s49, s53, 1537
    v_cmp_ne_u32 vcc, s48, v230
    v_cmp_ne_u32 s[50:51], s49, v230
    s_and_b64 exec, vcc, s[50:51]
    global_store_dword v232, v25, s[36:37] offset:1024
    s_mov_b64 exec, -1
    ds_write_b64 v242, v[24:25] offset:48896
    s_waitcnt lgkmcnt(0)
    s_cmp_eq_u32 s54, 0
    s_cbranch_scc1 L_fix_skip0
    s_lshl_b32 s50, s52, 2
    v_mov_b32 v77, s50
    ds_read_b32 v79, v77 offset:42752
    s_lshr_b32 s50, s72, 16
    s_lshr_b32 s51, s50, 15
    s_cmp_eq_u32 s51, 1
    s_mov_b32 s51, 0xffff
    s_cselect_b32 s51, 0x8000, s51
    s_xor_b32 s50, s50, s51
    s_lshl_b32 s50, s50, 16
    v_mov_b32 v92, 0xbfb8aa3b
    v_mul_f32 v92, s50, v92
    v_exp_f32 v92, v92
    s_nop 0
    v_add_f32 v92, 1.0, v92
    v_rcp_f32 v92, v92
    s_nop 0
    v_cvt_pk_bf16_f32 v92, v92, v92
    v_lshlrev_b32 v92, 16, v92
    s_mov_b32 s64, 0
    s_waitcnt vmcnt(2)
    s_branch L_fixchk0
L_fixpoll0:
    s_sleep 2
    global_load_dwordx4 v[192:195], v208, s[70:71] sc1
    s_bfm_b64 exec, 48, 0
    global_load_dwordx4 v[196:199], v209, s[70:71] sc1
    s_mov_b64 exec, -1
    s_waitcnt vmcnt(0)
L_fixchk0:
    v_xor_b32 v88, s44, v193
    v_xor_b32 v89, s44, v195
    v_xor_b32 v93, s44, v197
    v_xor_b32 v94, s44, v199
    v_or3_b32 v88, v88, v89, v93
    v_or_b32 v88, v88, v94
    v_cmp_ne_u32 vcc, 0, v88
    s_add_u32 s64, s64, 1
    s_cmp_eq_u64 vcc, 0
    s_cbranch_scc1 L_fixdone0
    s_cmp_lt_u32 s64, 40000
    s_cbranch_scc1 L_fixpoll0
L_fixdone0:
    v_add_f32 v80, v192, v196
    v_add_f32 v82, v194, v198
    s_nop 0
    s_nop 0
    v_add_f32_dpp v80, v80, v80 quad_perm:[1,0,3,2] row_mask:0xf bank_mask:0xf
    v_add_f32_dpp v82, v82, v82 quad_perm:[1,0,3,2] row_mask:0xf bank_mask:0xf
    s_nop 0
    v_add_f32_dpp v80, v80, v80 quad_perm:[2,3,0,1] row_mask:0xf bank_mask:0xf
    v_add_f32_dpp v82, v82, v82 quad_perm:[2,3,0,1] row_mask:0xf bank_mask:0xf
    s_nop 0
    v_add_f32_dpp v80, v80, v80 row_half_mirror row_mask:0xf bank_mask:0xf
    v_add_f32_dpp v82, v82, v82 row_half_mirror row_mask:0xf bank_mask:0xf
    s_nop 0
    v_add_f32_dpp v80, v80, v80 row_mirror row_mask:0xf bank_mask:0xf
    v_add_f32_dpp v82, v82, v82 row_mirror row_mask:0xf bank_mask:0xf
    s_nop 0
    v_add_f32_dpp v80, v80, v80 row_bcast:15 row_mask:0xa bank_mask:0xf
    v_add_f32_dpp v82, v82, v82 row_bcast:15 row_mask:0xa bank_mask:0xf
    s_nop 0
    v_add_f32_dpp v80, v80, v80 row_bcast:31 row_mask:0xc bank_mask:0xf
    v_add_f32_dpp v82, v82, v82 row_bcast:31 row_mask:0xc bank_mask:0xf
    s_nop 0
    v_cvt_pk_bf16_f32 v84, v80, v82
    v_lshlrev_b32 v80, 16, v84
    v_and_b32 v81, s74, v84
    s_waitcnt lgkmcnt(0)
    v_lshlrev_b32 v82, 16, v79
    v_and_b32 v83, s74, v79
    v_pk_fma_f32 v[80:81], v[80:81], v[92:93], v[82:83] op_sel_hi:[1,0,1]
    v_cvt_pk_bf16_f32 v84, v80, v81
    s_lshl_b32 s49, s52, 10
    s_lshl_b32 s50, s43, 2
    s_add_u32 s49, s49, s50
    v_mov_b32 v86, s49
    s_lshl_b64 exec, 1, 63
    global_store_dword v86, v84, s[36:37]
    s_mov_b64 exec, -1
L_fix_skip0:
    s_cmp_eq_u32 s55, 0
    s_cbranch_scc1 L_fix_skip1
    s_lshl_b32 s50, s53, 2
    v_mov_b32 v77, s50
    ds_read_b32 v79, v77 offset:42752
    s_lshr_b32 s50, s73, 16
    s_lshr_b32 s51, s50, 15
    s_cmp_eq_u32 s51, 1
    s_mov_b32 s51, 0xffff
    s_cselect_b32 s51, 0x8000, s51
    s_xor_b32 s50, s50, s51
    s_lshl_b32 s50, s50, 16
    v_mov_b32 v92, 0xbfb8aa3b
    v_mul_f32 v92, s50, v92
    v_exp_f32 v92, v92
    s_nop 0
    v_add_f32 v92, 1.0, v92
    v_rcp_f32 v92, v92
    s_nop 0
    v_cvt_pk_bf16_f32 v92, v92, v92
    v_lshlrev_b32 v92, 16, v92
    s_mov_b32 s64, 0
    s_waitcnt vmcnt(2)
    s_branch L_fixchk1
L_fixpoll1:
    s_sleep 2
    global_load_dwordx4 v[200:203], v210, s[70:71] sc1
    s_bfm_b64 exec, 48, 0
    global_load_dwordx4 v[204:207], v211, s[70:71] sc1
    s_mov_b64 exec, -1
    s_waitcnt vmcnt(0)
L_fixchk1:
    v_xor_b32 v88, s44, v201
    v_xor_b32 v89, s44, v203
    v_xor_b32 v93, s44, v205
    v_xor_b32 v94, s44, v207
    v_or3_b32 v88, v88, v89, v93
    v_or_b32 v88, v88, v94
    v_cmp_ne_u32 vcc, 0, v88
    s_add_u32 s64, s64, 1
    s_cmp_eq_u64 vcc, 0
    s_cbranch_scc1 L_fixdone1
    s_cmp_lt_u32 s64, 40000
    s_cbranch_scc1 L_fixpoll1
L_fixdone1:
    v_add_f32 v80, v200, v204
    v_add_f32 v82, v202, v206
    s_nop 0
    s_nop 0
    v_add_f32_dpp v80, v80, v80 quad_perm:[1,0,3,2] row_mask:0xf bank_mask:0xf
    v_add_f32_dpp v82, v82, v82 quad_perm:[1,0,3,2] row_mask:0xf bank_mask:0xf
    s_nop 0
    v_add_f32_dpp v80, v80, v80 quad_perm:[2,3,0,1] row_mask:0xf bank_mask:0xf
    v_add_f32_dpp v82, v82, v82 quad_perm:[2,3,0,1] row_mask:0xf bank_mask:0xf
    s_nop 0
    v_add_f32_dpp v80, v80, v80 row_half_mirror row_mask:0xf bank_mask:0xf
    v_add_f32_dpp v82, v82, v82 row_half_mirror row_mask:0xf bank_mask:0xf
    s_nop 0
    v_add_f32_dpp v80, v80, v80 row_mirror row_mask:0xf bank_mask:0xf
    v_add_f32_dpp v82, v82, v82 row_mirror row_mask:0xf bank_mask:0xf
    s_nop 0
    v_add_f32_dpp v80, v80, v80 row_bcast:15 row_mask:0xa bank_mask:0xf
    v_add_f32_dpp v82, v82, v82 row_bcast:15 row_mask:0xa bank_mask:0xf
    s_nop 0
    v_add_f32_dpp v80, v80, v80 row_bcast:31 row_mask:0xc bank_mask:0xf
    v_add_f32_dpp v82, v82, v82 row_bcast:31 row_mask:0xc bank_mask:0xf
    s_nop 0
    v_cvt_pk_bf16_f32 v84, v80, v82
    v_lshlrev_b32 v80, 16, v84
    v_and_b32 v81, s74, v84
    s_waitcnt lgkmcnt(0)
    v_lshlrev_b32 v82, 16, v79
    v_and_b32 v83, s74, v79
    v_pk_fma_f32 v[80:81], v[80:81], v[92:93], v[82:83] op_sel_hi:[1,0,1]
    v_cvt_pk_bf16_f32 v85, v80, v81
    s_lshl_b32 s49, s53, 10
    s_lshl_b32 s50, s43, 2
    s_add_u32 s49, s49, s50
    v_mov_b32 v87, s49
    s_lshl_b64 exec, 1, 63
    global_store_dword v87, v85, s[36:37]
    s_mov_b64 exec, -1
L_fix_skip1:
    s_branch L_fin
L_ffn:
    s_sub_u32 s48, s2, 384
    s_and_b32 s49, s48, 7
    s_mul_i32 s49, s49, 14
    s_lshr_b32 s48, s48, 3
    s_add_u32 s47, s48, s49
    v_lshlrev_b32 v15, 4, v0
    v_lshrrev_b32 v12, 2, v0
    v_mul_u32_u24 v12, 3584, v12
    v_and_b32 v13, 1, v0
    v_lshl_add_u32 v12, v13, 4, v12
    s_lshl_b32 s48, s47, 5
    v_add_u32 v12, s48, v12
    v_and_b32 v13, 2, v0
    v_cmp_eq_u32 vcc, 0, v13
    s_waitcnt lgkmcnt(0)
    v_mov_b32 v16, s32
    v_mov_b32 v17, s33
    v_mov_b32 v18, s30
    v_mov_b32 v19, s31
    v_cndmask_b32 v16, v16, v18, vcc
    v_cndmask_b32 v17, v17, v19, vcc
    v_add_co_u32 v16, vcc, v16, v12
    s_nop 1
    v_addc_co_u32 v17, vcc, v17, v2, vcc
    s_add_u32 s70, s40, 65536
    s_addc_u32 s71, s41, 0
    s_mov_b32 s49, 229376
    s_lshl_b32 s48, s47, 14
    v_lshl_add_u32 v14, v0, 2, s48
    global_load_dwordx4 v[32:35], v[16:17], off
    v_add_co_u32 v16, vcc, s49, v16
    s_nop 1
    v_addc_co_u32 v17, vcc, v17, v2, vcc
    global_load_dwordx4 v[36:39], v[16:17], off
    v_add_co_u32 v16, vcc, s49, v16
    s_nop 1
    v_addc_co_u32 v17, vcc, v17, v2, vcc
    global_load_dwordx4 v[40:43], v[16:17], off
    v_add_co_u32 v16, vcc, s49, v16
    s_nop 1
    v_addc_co_u32 v17, vcc, v17, v2, vcc
    global_load_dwordx4 v[44:47], v[16:17], off
    v_add_co_u32 v16, vcc, s49, v16
    s_nop 1
    v_addc_co_u32 v17, vcc, v17, v2, vcc
    global_load_dwordx4 v[48:51], v[16:17], off
    v_add_co_u32 v16, vcc, s49, v16
    s_nop 1
    v_addc_co_u32 v17, vcc, v17, v2, vcc
    global_load_dwordx4 v[52:55], v[16:17], off
    v_add_co_u32 v16, vcc, s49, v16
    s_nop 1
    v_addc_co_u32 v17, vcc, v17, v2, vcc
    global_load_dwordx4 v[56:59], v[16:17], off
    v_add_co_u32 v16, vcc, s49, v16
    s_nop 1
    v_addc_co_u32 v17, vcc, v17, v2, vcc
    global_load_dwordx4 v[60:63], v[16:17], off
    global_load_dword v96, v14, s[34:35] offset:0
    global_load_dword v97, v14, s[34:35] offset:1024
    global_load_dword v98, v14, s[34:35] offset:2048
    global_load_dword v99, v14, s[34:35] offset:3072
    v_add_u32 v14, 4096, v14
    global_load_dword v100, v14, s[34:35] offset:0
    global_load_dword v101, v14, s[34:35] offset:1024
    global_load_dword v102, v14, s[34:35] offset:2048
    global_load_dword v103, v14, s[34:35] offset:3072
    v_add_u32 v14, 4096, v14
    global_load_dword v104, v14, s[34:35] offset:0
    global_load_dword v105, v14, s[34:35] offset:1024
    global_load_dword v106, v14, s[34:35] offset:2048
    global_load_dword v107, v14, s[34:35] offset:3072
    v_add_u32 v14, 4096, v14
    global_load_dword v108, v14, s[34:35] offset:0
    global_load_dword v109, v14, s[34:35] offset:1024
    global_load_dword v110, v14, s[34:35] offset:2048
    global_load_dword v111, v14, s[34:35] offset:3072
    global_load_dword v22, v2, s[38:39] sc1
    s_waitcnt vmcnt(24)
    ds_write_b128 v15, v[32:35] offset:2560
    s_waitcnt vmcnt(23)
    ds_write_b128 v15, v[36:39] offset:6656
    s_waitcnt vmcnt(22)
    ds_write_b128 v15, v[40:43] offset:10752
    s_waitcnt vmcnt(21)
    ds_write_b128 v15, v[44:47] offset:14848
    s_waitcnt vmcnt(20)
    ds_write_b128 v15, v[48:51] offset:18944
    s_waitcnt vmcnt(19)
    ds_write_b128 v15, v[52:55] offset:23040
    s_waitcnt vmcnt(18)
    ds_write_b128 v15, v[56:59] offset:27136
    s_waitcnt vmcnt(17)
    ds_write_b128 v15, v[60:63] offset:31232
    v_lshrrev_b32 v12, 2, v5
    v_lshl_add_u32 v12, v6, 3, v12
    v_lshlrev_b32 v12, 6, v12
    v_and_b32 v13, 1, v1
    v_lshl_add_u32 v12, v13, 3, v12
    v_and_b32 v13, 2, v1
    v_lshl_add_u32 v12, v13, 4, v12
    s_and_b32 s48, s42, 1
    s_lshl_b32 s48, s48, 4
    v_add_u32 v12, s48, v12
    s_waitcnt lgkmcnt(0)
    s_barrier
    ds_read_b64_tr_b16 v[32:33], v12 offset:2560
    ds_read_b64_tr_b16 v[34:35], v12 offset:2816
    ds_read_b64_tr_b16 v[36:37], v12 offset:4608
    ds_read_b64_tr_b16 v[38:39], v12 offset:4864
    ds_read_b64_tr_b16 v[40:41], v12 offset:6656
    ds_read_b64_tr_b16 v[42:43], v12 offset:6912
    ds_read_b64_tr_b16 v[44:45], v12 offset:8704
    ds_read_b64_tr_b16 v[46:47], v12 offset:8960
    ds_read_b64_tr_b16 v[48:49], v12 offset:10752
    ds_read_b64_tr_b16 v[50:51], v12 offset:11008
    ds_read_b64_tr_b16 v[52:53], v12 offset:12800
    ds_read_b64_tr_b16 v[54:55], v12 offset:13056
    ds_read_b64_tr_b16 v[56:57], v12 offset:14848
    ds_read_b64_tr_b16 v[58:59], v12 offset:15104
    ds_read_b64_tr_b16 v[60:61], v12 offset:16896
    ds_read_b64_tr_b16 v[62:63], v12 offset:17152
    ds_read_b64_tr_b16 v[64:65], v12 offset:18944
    ds_read_b64_tr_b16 v[66:67], v12 offset:19200
    ds_read_b64_tr_b16 v[68:69], v12 offset:20992
    ds_read_b64_tr_b16 v[70:71], v12 offset:21248
    ds_read_b64_tr_b16 v[72:73], v12 offset:23040
    ds_read_b64_tr_b16 v[74:75], v12 offset:23296
    ds_read_b64_tr_b16 v[76:77], v12 offset:25088
    ds_read_b64_tr_b16 v[78:79], v12 offset:25344
    ds_read_b64_tr_b16 v[80:81], v12 offset:27136
    ds_read_b64_tr_b16 v[82:83], v12 offset:27392
    ds_read_b64_tr_b16 v[84:85], v12 offset:29184
    ds_read_b64_tr_b16 v[86:87], v12 offset:29440
    ds_read_b64_tr_b16 v[88:89], v12 offset:31232
    ds_read_b64_tr_b16 v[90:91], v12 offset:31488
    ds_read_b64_tr_b16 v[92:93], v12 offset:33280
    ds_read_b64_tr_b16 v[94:95], v12 offset:33536
    s_mov_b32 s64, 0
L_npoll_6:
    s_waitcnt vmcnt(0)
L_npoll_6_chk:
    v_readfirstlane_b32 s44, v22
    s_add_u32 s64, s64, 1
    s_cmp_lg_u32 s44, 0
    s_cbranch_scc1 L_npoll_6_done
    s_cmp_ge_u32 s64, 40000
    s_cbranch_scc1 L_npoll_6_done
    s_sleep 1
    global_load_dword v22, v2, s[38:39] sc1
    s_branch L_npoll_6
L_npoll_6_done:
    v_lshlrev_b32 v128, 16, v96
    v_and_b32 v129, s74, v96
    v_lshlrev_b32 v130, 16, v97
    v_and_b32 v131, s74, v97
    v_lshlrev_b32 v132, 16, v98
    v_and_b32 v133, s74, v98
    v_lshlrev_b32 v134, 16, v99
    v_and_b32 v135, s74, v99
    v_lshlrev_b32 v136, 16, v100
    v_and_b32 v137, s74, v100
    v_lshlrev_b32 v138, 16, v101
    v_and_b32 v139, s74, v101
    v_lshlrev_b32 v140, 16, v102
    v_and_b32 v141, s74, v102
    v_lshlrev_b32 v142, 16, v103
    v_and_b32 v143, s74, v103
    v_lshlrev_b32 v144, 16, v104
    v_and_b32 v145, s74, v104
    v_lshlrev_b32 v146, 16, v105
    v_and_b32 v147, s74, v105
    v_lshlrev_b32 v148, 16, v106
    v_and_b32 v149, s74, v106
    v_lshlrev_b32 v150, 16, v107
    v_and_b32 v151, s74, v107
    v_lshlrev_b32 v152, 16, v108
    v_and_b32 v153, s74, v108
    v_lshlrev_b32 v154, 16, v109
    v_and_b32 v155, s74, v109
    v_lshlrev_b32 v156, 16, v110
    v_and_b32 v157, s74, v110
    v_lshlrev_b32 v158, 16, v111
    v_and_b32 v159, s74, v111
    v_bfe_u32 v13, v5, 2, 1
    v_lshlrev_b32 v13, 10, v13
    v_lshl_add_u32 v13, v6, 4, v13
    s_and_b32 s49, s42, 1
    s_lshl_b32 s49, s49, 9
    v_lshl_add_u32 v24, v1, 3, s49
    s_lshr_b32 s48, s42, 1
    s_lshl_b32 s49, s48, 10
    v_add_u32 v25, s49, v24
    s_waitcnt lgkmcnt(0)
    s_setprio 3
    s_cmp_lg_u32 s42, 0
    s_cbranch_scc1 L_fk_wait
    s_mov_b32 s64, 0
L_kpoll_7:
    global_load_dwordx4 v[192:195], v252, s[40:41] sc1
    global_load_dwordx4 v[196:199], v253, s[40:41] sc1
    s_waitcnt vmcnt(0)
    v_xor_b32 v20, s44, v193
    v_xor_b32 v21, s44, v195
    v_xor_b32 v22, s44, v197
    v_xor_b32 v23, s44, v199
    v_or3_b32 v20, v20, v22, v23
    v_or_b32 v20, v20, v21
    v_cmp_ne_u32 vcc, 0, v20
    s_add_u32 s64, s64, 1
    s_cmp_eq_u64 vcc, 0
    s_cbranch_scc1 L_kpoll_7_done
    s_sleep 6
    s_cmp_lt_u32 s64, 40000
    s_cbranch_scc1 L_kpoll_7
L_kpoll_7_done:
    v_max_u32 v22, v194, v198
    v_med3_u32 v194, v192, v196, v22
    v_max_u32 v192, v192, v196
    v_mov_b32 v224, v192
    v_mov_b32 v225, v194
    s_nop 1
    v_mov_b32_dpp v21, v224 quad_perm:[1,0,3,2] row_mask:0xf bank_mask:0xf
    v_max_u32_dpp v22, v225, v225 quad_perm:[1,0,3,2] row_mask:0xf bank_mask:0xf
    v_med3_u32 v225, v224, v21, v22
    v_max_u32 v224, v224, v21
    s_nop 1
    v_mov_b32_dpp v21, v224 quad_perm:[2,3,0,1] row_mask:0xf bank_mask:0xf
    v_max_u32_dpp v22, v225, v225 quad_perm:[2,3,0,1] row_mask:0xf bank_mask:0xf
    v_med3_u32 v225, v224, v21, v22
    v_max_u32 v224, v224, v21
    s_nop 1
    v_mov_b32_dpp v21, v224 row_half_mirror row_mask:0xf bank_mask:0xf
    v_max_u32_dpp v22, v225, v225 row_half_mirror row_mask:0xf bank_mask:0xf
    v_med3_u32 v225, v224, v21, v22
    v_max_u32 v224, v224, v21
    s_nop 1
    v_mov_b32_dpp v21, v224 row_mirror row_mask:0xf bank_mask:0xf
    v_max_u32_dpp v22, v225, v225 row_mirror row_mask:0xf bank_mask:0xf
    v_med3_u32 v225, v224, v21, v22
    v_max_u32 v224, v224, v21
    v_mov_b32 v21, v224
    v_mov_b32 v22, v225
    s_nop 1
    v_permlane16_swap_b32 v224, v21
    v_permlane16_swap_b32 v225, v22
    s_nop 0
    v_max_u32 v22, v225, v22
    v_med3_u32 v225, v224, v21, v22
    v_max_u32 v224, v224, v21
    v_mov_b32 v21, v224
    v_mov_b32 v22, v225
    s_nop 1
    v_permlane32_swap_b32 v224, v21
    v_permlane32_swap_b32 v225, v22
    s_nop 0
    v_max_u32 v22, v225, v22
    v_med3_u32 v225, v224, v21, v22
    v_max_u32 v224, v224, v21
    s_nop 0
    v_readfirstlane_b32 s72, v224
    v_readfirstlane_b32 s73, v225
    ds_write_b64 v2, v[224:225] offset:16
    s_waitcnt lgkmcnt(0)
L_fk_wait:
    s_barrier
    ds_read_b64 v[224:225], v2 offset:16
    s_waitcnt lgkmcnt(0)
    v_readfirstlane_b32 s72, v224
    v_readfirstlane_b32 s73, v225
    s_cmp_lt_u32 s42, 2
    s_nop 2
    s_cselect_b32 s48, s72, s73
    s_and_b32 s48, s48, 0xffff
    s_sub_u32 s48, 0xffff, s48
    s_min_u32 s48, s48, 2047
    s_lshl_b32 s49, s48, 10
    v_add_u32 v97, s49, v24
    s_lshl_b32 s49, s48, 3
    v_mov_b32 v99, s49
    global_load_dwordx2 v[100:101], v97, s[8:9]
    s_mov_b32 s64, 0
L_f_stat:
    global_load_dwordx2 v[104:105], v99, s[40:41] sc1
    s_waitcnt vmcnt(0)
    v_cmp_ne_u32 vcc, s44, v105
    s_add_u32 s64, s64, 1
    s_cmp_eq_u64 vcc, 0
    s_cbranch_scc1 L_f_stat_done
    s_sleep 1
    s_cmp_lt_u32 s64, 40000
    s_cbranch_scc1 L_f_stat
L_f_stat_done:
    v_and_b32 v106, s74, v104
    v_lshlrev_b32 v104, 16, v104
    v_rcp_f32 v106, v106
    v_lshlrev_b32 v108, 16, v100
    v_and_b32 v109, s74, v100
    v_lshlrev_b32 v110, 16, v101
    v_and_b32 v111, s74, v101
    v_pk_add_f32 v[108:109], v[108:109], v[104:105] op_sel_hi:[1,0] neg_lo:[0,1] neg_hi:[0,1]
    v_pk_add_f32 v[110:111], v[110:111], v[104:105] op_sel_hi:[1,0] neg_lo:[0,1] neg_hi:[0,1]
    v_cvt_pk_bf16_f32 v100, v108, v109
    v_cvt_pk_bf16_f32 v101, v110, v111
    v_lshlrev_b32 v108, 16, v100
    v_and_b32 v109, s74, v100
    v_lshlrev_b32 v110, 16, v101
    v_and_b32 v111, s74, v101
    v_pk_mul_f32 v[108:109], v[108:109], v[106:107] op_sel_hi:[1,0]
    v_pk_mul_f32 v[110:111], v[110:111], v[106:107] op_sel_hi:[1,0]
    v_cvt_pk_bf16_f32 v100, v108, v109
    v_cvt_pk_bf16_f32 v101, v110, v111
    ds_write_b64 v25, v[100:101] offset:512
    s_waitcnt lgkmcnt(0)
    s_barrier
    s_cmp_ge_u32 s42, 2
    s_cbranch_scc1 L_f_nogu
    ds_read_b128 v[160:163], v13 offset:512
    ds_read_b128 v[164:167], v13 offset:576
    ds_read_b128 v[168:171], v13 offset:640
    ds_read_b128 v[172:175], v13 offset:704
    ds_read_b128 v[176:179], v13 offset:768
    ds_read_b128 v[180:183], v13 offset:832
    ds_read_b128 v[184:187], v13 offset:896
    ds_read_b128 v[188:191], v13 offset:960
    ds_read_b128 v[192:195], v13 offset:1024
    ds_read_b128 v[196:199], v13 offset:1088
    ds_read_b128 v[200:203], v13 offset:1152
    ds_read_b128 v[204:207], v13 offset:1216
    ds_read_b128 v[208:211], v13 offset:1280
    ds_read_b128 v[212:215], v13 offset:1344
    ds_read_b128 v[216:219], v13 offset:1408
    ds_read_b128 v[220:223], v13 offset:1472
    s_waitcnt lgkmcnt(15)
    v_mfma_f32_16x16x32_bf16 v[96:99], v[160:163], v[32:35], 0
    s_waitcnt lgkmcnt(14)
    v_mfma_f32_16x16x32_bf16 v[100:103], v[164:167], v[36:39], 0
    s_waitcnt lgkmcnt(13)
    v_mfma_f32_16x16x32_bf16 v[96:99], v[168:171], v[40:43], v[96:99]
    s_waitcnt lgkmcnt(12)
    v_mfma_f32_16x16x32_bf16 v[100:103], v[172:175], v[44:47], v[100:103]
    s_waitcnt lgkmcnt(11)
    v_mfma_f32_16x16x32_bf16 v[96:99], v[176:179], v[48:51], v[96:99]
    s_waitcnt lgkmcnt(10)
    v_mfma_f32_16x16x32_bf16 v[100:103], v[180:183], v[52:55], v[100:103]
    s_waitcnt lgkmcnt(9)
    v_mfma_f32_16x16x32_bf16 v[96:99], v[184:187], v[56:59], v[96:99]
    s_waitcnt lgkmcnt(8)
    v_mfma_f32_16x16x32_bf16 v[100:103], v[188:191], v[60:63], v[100:103]
    s_waitcnt lgkmcnt(7)
    v_mfma_f32_16x16x32_bf16 v[96:99], v[192:195], v[64:67], v[96:99]
    s_waitcnt lgkmcnt(6)
    v_mfma_f32_16x16x32_bf16 v[100:103], v[196:199], v[68:71], v[100:103]
    s_waitcnt lgkmcnt(5)
    v_mfma_f32_16x16x32_bf16 v[96:99], v[200:203], v[72:75], v[96:99]
    s_waitcnt lgkmcnt(4)
    v_mfma_f32_16x16x32_bf16 v[100:103], v[204:207], v[76:79], v[100:103]
    s_waitcnt lgkmcnt(3)
    v_mfma_f32_16x16x32_bf16 v[96:99], v[208:211], v[80:83], v[96:99]
    s_waitcnt lgkmcnt(2)
    v_mfma_f32_16x16x32_bf16 v[100:103], v[212:215], v[84:87], v[100:103]
    s_waitcnt lgkmcnt(1)
    v_mfma_f32_16x16x32_bf16 v[96:99], v[216:219], v[88:91], v[96:99]
    s_waitcnt lgkmcnt(0)
    v_mfma_f32_16x16x32_bf16 v[100:103], v[220:223], v[92:95], v[100:103]
    v_lshlrev_b32 v107, 7, v6
    v_lshl_add_u32 v107, v5, 3, v107
    s_lshl_b32 s48, s42, 6
    v_add_u32 v107, s48, v107
    s_nop 4
    v_add_f32 v104, v96, v100
    v_cvt_pk_bf16_f32 v104, v104, v104
    v_lshlrev_b32 v104, 16, v104
    v_mul_f32 v105, 0xbfb8aa3b, v104
    v_exp_f32 v105, v105
    v_mov_b32_dpp v106, v104 row_ror:8 row_mask:0xf bank_mask:0xf
    v_add_f32 v105, 1.0, v105
    v_rcp_f32 v105, v105
    s_nop 0
    v_mul_f32 v105, v104, v105
    v_cvt_pk_bf16_f32 v105, v105, v105
    v_lshlrev_b32 v105, 16, v105
    v_mul_f32 v105, v105, v106
    v_cvt_pk_bf16_f32 v105, v105, v105
    v_lshlrev_b32 v105, 16, v105
    s_mov_b64 exec, 0x00ff00ff
    ds_write2_b32 v107, v105, v105 offset0:64 offset1:65
    s_mov_b64 exec, -1
    s_waitcnt lgkmcnt(0)
L_f_nogu:
    s_barrier
    ds_read_b128 v[160:163], v2 offset:256
    ds_read_b128 v[164:167], v2 offset:272
    ds_read_b128 v[168:171], v2 offset:288
    ds_read_b128 v[172:175], v2 offset:304
    ds_read_b128 v[176:179], v2 offset:320
    ds_read_b128 v[180:183], v2 offset:336
    ds_read_b128 v[184:187], v2 offset:352
    ds_read_b128 v[188:191], v2 offset:368
    ds_read_b128 v[192:195], v2 offset:384
    ds_read_b128 v[196:199], v2 offset:400
    ds_read_b128 v[200:203], v2 offset:416
    ds_read_b128 v[204:207], v2 offset:432
    ds_read_b128 v[208:211], v2 offset:448
    ds_read_b128 v[212:215], v2 offset:464
    ds_read_b128 v[216:219], v2 offset:480
    ds_read_b128 v[220:223], v2 offset:496
    s_lshl_b32 s48, s47, 12
    v_lshl_add_u32 v112, v0, 4, s48
    v_add_u32 v113, 0x80000, v112
    v_mov_b32 v97, s44
    v_mov_b32 v99, s44
    v_mov_b32 v101, s44
    v_mov_b32 v103, s44
    s_waitcnt lgkmcnt(15)
    v_pk_mul_f32 v[104:105], v[128:129], v[160:161]
    v_pk_mul_f32 v[106:107], v[130:131], v[162:163]
    s_waitcnt lgkmcnt(14)
    v_pk_fma_f32 v[104:105], v[132:133], v[164:165], v[104:105]
    v_pk_fma_f32 v[106:107], v[134:135], v[166:167], v[106:107]
    s_waitcnt lgkmcnt(13)
    v_pk_fma_f32 v[104:105], v[136:137], v[168:169], v[104:105]
    v_pk_fma_f32 v[106:107], v[138:139], v[170:171], v[106:107]
    s_waitcnt lgkmcnt(12)
    v_pk_fma_f32 v[104:105], v[140:141], v[172:173], v[104:105]
    v_pk_fma_f32 v[106:107], v[142:143], v[174:175], v[106:107]
    s_waitcnt lgkmcnt(11)
    v_pk_fma_f32 v[104:105], v[144:145], v[176:177], v[104:105]
    v_pk_fma_f32 v[106:107], v[146:147], v[178:179], v[106:107]
    s_waitcnt lgkmcnt(10)
    v_pk_fma_f32 v[104:105], v[148:149], v[180:181], v[104:105]
    v_pk_fma_f32 v[106:107], v[150:151], v[182:183], v[106:107]
    s_waitcnt lgkmcnt(9)
    v_pk_fma_f32 v[104:105], v[152:153], v[184:185], v[104:105]
    v_pk_fma_f32 v[106:107], v[154:155], v[186:187], v[106:107]
    s_waitcnt lgkmcnt(8)
    v_pk_fma_f32 v[104:105], v[156:157], v[188:189], v[104:105]
    v_pk_fma_f32 v[106:107], v[158:159], v[190:191], v[106:107]
    v_add_f32 v96, v104, v106
    v_add_f32 v98, v105, v107
    global_store_dwordx4 v112, v[96:99], s[70:71] sc1
    s_waitcnt lgkmcnt(7)
    v_pk_mul_f32 v[108:109], v[128:129], v[192:193]
    v_pk_mul_f32 v[110:111], v[130:131], v[194:195]
    s_waitcnt lgkmcnt(6)
    v_pk_fma_f32 v[108:109], v[132:133], v[196:197], v[108:109]
    v_pk_fma_f32 v[110:111], v[134:135], v[198:199], v[110:111]
    s_waitcnt lgkmcnt(5)
    v_pk_fma_f32 v[108:109], v[136:137], v[200:201], v[108:109]
    v_pk_fma_f32 v[110:111], v[138:139], v[202:203], v[110:111]
    s_waitcnt lgkmcnt(4)
    v_pk_fma_f32 v[108:109], v[140:141], v[204:205], v[108:109]
    v_pk_fma_f32 v[110:111], v[142:143], v[206:207], v[110:111]
    s_waitcnt lgkmcnt(3)
    v_pk_fma_f32 v[108:109], v[144:145], v[208:209], v[108:109]
    v_pk_fma_f32 v[110:111], v[146:147], v[210:211], v[110:111]
    s_waitcnt lgkmcnt(2)
    v_pk_fma_f32 v[108:109], v[148:149], v[212:213], v[108:109]
    v_pk_fma_f32 v[110:111], v[150:151], v[214:215], v[110:111]
    s_waitcnt lgkmcnt(1)
    v_pk_fma_f32 v[108:109], v[152:153], v[216:217], v[108:109]
    v_pk_fma_f32 v[110:111], v[154:155], v[218:219], v[110:111]
    s_waitcnt lgkmcnt(0)
    v_pk_fma_f32 v[108:109], v[156:157], v[220:221], v[108:109]
    v_pk_fma_f32 v[110:111], v[158:159], v[222:223], v[110:111]
    v_add_f32 v100, v108, v110
    v_add_f32 v102, v109, v111
    global_store_dwordx4 v113, v[100:103], s[70:71] sc1
L_fin:
L_end:
    s_endpgm
.section .rodata,"a"
.p2align 6
.amdhsa_kernel parallel_sum__ssm_conv_s4__moe_arch_mod__prompt_kernel
  .amdhsa_next_free_vgpr 256
  .amdhsa_next_free_sgpr 102
  .amdhsa_accum_offset 256
  .amdhsa_group_segment_fixed_size 0
  .amdhsa_kernarg_size 136
  .amdhsa_user_sgpr_count 2
  .amdhsa_user_sgpr_kernarg_segment_ptr 1
  .amdhsa_system_sgpr_workgroup_id_x 1
  .amdhsa_float_denorm_mode_32 3
.end_amdhsa_kernel
```
